```python
import torch

def _softmax(x, axis=-1):
    return torch.softmax(x, dim=axis)
def _gelu(x):
    return torch.nn.functional.gelu(x, approximate="tanh")
def _silu(x):
    return torch.nn.functional.silu(x)
def _sigmoid(x):
    return torch.sigmoid(x)
def _layernorm(x, axis=-1, eps=1e-5):
    m = x.mean(dim=axis, keepdim=True)
    v = x.var(dim=axis, keepdim=True, unbiased=False)
    return (x - m) / torch.sqrt(v + eps)
def _scatter_add(tgt, idx, src, axis=0):
    return tgt.clone().index_add_(axis, idx, src)
def _segment_sum(src, seg, n):
    out = torch.zeros((n,) + src.shape[1:], dtype=src.dtype)
    return out.index_add_(0, seg, src)
def _pad(x, pw):
    flat = tuple(v for pair in reversed(pw) for v in pair)
    return torch.nn.functional.pad(x, flat)

kernel_name = 'concat_heads__ssm_conv_s5__grouped_kv_mqa__prompt'

def setup_inputs():

    _w = (lambda a: (lambda t: t.to(torch.bfloat16) if t.is_floating_point() else t)(torch.as_tensor(a)))
    def _A_setup():
        B, S, D = 1, 2048, 448
        P = D
        Lambda_re = -0.5 * (lambda _x: torch.exp(torch.as_tensor(_x)))((lambda *s: torch.randn(*s, dtype=torch.bfloat16) * 0.4)(P))
        Lambda_im = (lambda *s: torch.randn(*s, dtype=torch.bfloat16) * 0.8)(P) * 1.0
        B_re = (lambda *s: torch.randn(*s, dtype=torch.bfloat16) * 0.4)(P, D) * (D ** -0.5)
        B_im = (lambda *s: torch.randn(*s, dtype=torch.bfloat16) * 0.4)(P, D) * (D ** -0.5)
        C_re = (lambda *s: torch.randn(*s, dtype=torch.bfloat16) * 0.4)(D, P) * (P ** -0.5)
        C_im = (lambda *s: torch.randn(*s, dtype=torch.bfloat16) * 0.4)(D, P) * (P ** -0.5)
        log_dt = (lambda *s: torch.randn(*s, dtype=torch.bfloat16) * 0.4)(P) * 0.3 - 2.0
        Dskip = (lambda *s: torch.randn(*s, dtype=torch.bfloat16) * 0.1)(D)
        return {
            "x": _w((lambda *s: torch.randn(*s, dtype=torch.bfloat16) * 0.05)(B, S, D)),
            "Lambda_re": _w(Lambda_re),
            "Lambda_im": _w(Lambda_im),
            "B_re": _w(B_re),
            "B_im": _w(B_im),
            "C_re": _w(C_re),
            "C_im": _w(C_im),
            "log_dt": _w(log_dt),
            "Dskip": _w(Dskip),
        }
    _A_in = _A_setup()

    def _B_setup():
        B, S, D, H = 1, 2048, 448, 16
        Dh = D // H
        return {
            "x": _w((lambda *s: torch.randn(*s, dtype=torch.bfloat16) * 0.05)(B, S, D)),
            "wq": _w((lambda *s: torch.randn(*s, dtype=torch.bfloat16) * 1.6)(D, H * Dh)),
            "wk": _w((lambda *s: torch.randn(*s, dtype=torch.bfloat16) * 1.6)(D, Dh)),
            "wv": _w((lambda *s: torch.randn(*s, dtype=torch.bfloat16) * 0.05)(D, Dh)),
            "wo": _w((lambda *s: torch.randn(*s, dtype=torch.bfloat16) * 0.05)(H * Dh, D)),
        }
    _B_in = _B_setup()

    return {
        "A_x": _A_in["x"],
        "A_Lambda_re": _A_in["Lambda_re"],
        "A_Lambda_im": _A_in["Lambda_im"],
        "A_B_re": _A_in["B_re"],
        "A_B_im": _A_in["B_im"],
        "A_C_re": _A_in["C_re"],
        "A_C_im": _A_in["C_im"],
        "A_log_dt": _A_in["log_dt"],
        "A_Dskip": _A_in["Dskip"],
        "B_x": _B_in["x"],
        "B_wq": _B_in["wq"],
        "B_wk": _B_in["wk"],
        "B_wv": _B_in["wv"],
        "B_wo": _B_in["wo"],
    }

def reference(A_x, A_Lambda_re, A_Lambda_im, A_B_re, A_B_im, A_C_re, A_C_im, A_log_dt, A_Dskip, B_x, B_wq, B_wk, B_wv, B_wo):
    def _A_ref(x, Lambda_re, Lambda_im, B_re, B_im, C_re, C_im, log_dt, Dskip):
        Bsz, L, H = x.shape
        Lam = Lambda_re + 1j * Lambda_im
        Bmat = B_re + 1j * B_im
        Cmat = C_re + 1j * C_im
        dt = torch.exp(log_dt)
        Lam_bar = torch.exp(dt * Lam)
        B_bar = ((Lam_bar - 1.0) / Lam)[:, None] * Bmat
        Bu = torch.einsum("bld,pd->blp", x + 0j, B_bar)
        h = torch.zeros_like(Bu[:, 0, :])
        hs = []
        for t in range(L):
            h = Lam_bar[None, :] * h + Bu[:, t, :]
            hs.append(h)
        hseq = torch.stack(hs, 1)
        y = 2.0 * torch.einsum("blp,dp->bld", hseq, Cmat).real + x * Dskip[None, None, :]
        return y

    def _B_ref(x, wq, wk, wv, wo):
        B, S, D = x.shape
        H = 16
        Dh = D // H
        q = (lambda x, *d: x.permute(*d))((x @ wq).reshape(B, S, H, Dh), 0, 2, 1, 3)
        k = x @ wk
        v = x @ wv
        scores = torch.einsum("bhqd,bkd->bhqk", q, k) * (Dh ** -0.5)
        p = _softmax(scores, axis=-1)
        o = torch.einsum("bhqk,bkd->bhqd", p, v)
        return (lambda x, *d: x.permute(*d))(o, 0, 2, 1, 3).reshape(B, S, H * Dh) @ wo

    a = _A_ref(A_x, A_Lambda_re, A_Lambda_im, A_B_re, A_B_im, A_C_re, A_C_im, A_log_dt, A_Dskip)
    b = _B_ref(B_x, B_wq, B_wk, B_wv, B_wo)
    return torch.concatenate([a, b], axis=-1)
```

```asm
; @launch grid=(256,1,1) block=(512,1,1) lds=163840
.amdgcn_target "amdgcn-amd-amdhsa--gfx950"
.text
.globl concat_heads__ssm_conv_s5__grouped_kv_mqa__prompt_kernel
.p2align 8
.type concat_heads__ssm_conv_s5__grouped_kv_mqa__prompt_kernel,@function
concat_heads__ssm_conv_s5__grouped_kv_mqa__prompt_kernel:
    s_cmp_ge_u32 s2, 256
    s_cbranch_scc1 F_END
    s_load_dwordx16 s[16:31], s[0:1], 0
    s_load_dwordx16 s[32:47], s[0:1], 64
    s_load_dwordx2 s[48:49], s[0:1], 128
    s_memrealtime s[6:7]
    v_lshrrev_b32 v5, 6, v0
    v_and_b32 v1, 63, v0
    v_readfirstlane_b32 s3, v5
    v_and_b32 v2, 15, v0
    v_bfe_u32 v3, v0, 4, 2
    v_lshlrev_b32 v4, 4, v1
    v_mov_b32 v14, 163584
    v_mov_b32 v15, 1
    v_lshl_add_u32 v5, v1, 2, v14
    v_mov_b32 v6, 0
    ds_write_b32 v5, v6
    s_and_b32 s4, s2, 7
    s_lshr_b32 s12, s2, 3
    s_getpc_b64 s[10:11]
    s_lshl_b32 s9, s12, 10
    v_and_b32 v5, 7, v0
    v_lshl_add_u32 v5, v5, 7, s9
    s_cmp_lg_u32 s3, 3
    s_cbranch_scc1 F_NPF
    global_load_dword v8, v5, s[10:11]
F_NPF:
    s_lshr_b32 s8, s12, 3
    s_lshl_b32 s50, s4, 2
    s_add_u32 s50, s50, s8
    s_and_b32 s51, s12, 7
    s_and_b32 s5, s3, 3
    s_lshl_b32 s8, s8, 1
    s_add_u32 s8, s8, s51
    s_add_u32 s8, s8, s4
    s_mul_i32 s9, s8, 9363
    s_lshr_b32 s9, s9, 16
    s_mul_i32 s9, s9, 7
    s_sub_u32 s76, s8, s9
    s_mul_i32 s9, s12, 98
    s_mul_i32 s8, s5, 25
    s_add_u32 s9, s9, s8
    v_add_u32 v5, s9, v1
    v_lshlrev_b32 v5, 7, v5
    v_cmp_gt_u32 vcc, 25, v1
    v_mov_b32 v6, 0x7f000000
    s_nop 0
    v_cndmask_b32 v0, v6, v5, vcc
    s_cmp_lt_u32 s3, 4
    s_cbranch_scc1 F_B
    s_setprio 3
    s_lshr_b32 s14, s51, 1
    s_lshl_b32 s8, s50, 6
    s_lshl_b32 s9, s14, 4
    s_add_u32 s8, s8, s9
    v_lshrrev_b32 v7, 3, v1
    v_add_u32 v7, s8, v7
    v_mul_u32_u24 v5, 896, v7
    v_and_b32 v6, 7, v1
    v_xor_b32 v6, v6, v3
    v_lshl_add_u32 v12, v6, 4, v5
    v_xor_b32 v6, 4, v6
    v_lshl_add_u32 v5, v6, 4, v5
    v_add_u32 v13, 7168, v5
    v_lshrrev_b32 v5, 2, v1
    v_mul_u32_u24 v5, 56, v5
    v_and_b32 v6, 2, v3
    v_and_b32 v7, 3, v1
    v_xor_b32 v6, v6, v7
    v_lshl_add_u32 v16, v6, 4, v5
    s_lshl_b32 s10, s5, 12
    s_add_u32 s10, s10, 57344
    s_lshl_b32 s11, s5, 13
    s_lshl_b32 s9, s14, 11
    s_add_u32 s11, s11, s9
    s_add_u32 s11, s11, 86016
    s_add_u32 s15, s76, s5
    s_lshl_b32 s8, s51, 6
    s_lshl_b32 s9, s5, 4
    s_add_u32 s9, s8, s9
    v_add_u32 v5, s9, v2
    v_min_u32 v5, 447, v5
    v_lshlrev_b32 v5, 1, v5
    s_and_b32 s9, s5, 1
    s_lshl_b32 s9, s9, 5
    s_add_u32 s9, s8, s9
    v_and_b32 v6, 31, v1
    v_add_u32 v6, s9, v6
    v_min_u32 v6, 447, v6
    v_lshlrev_b32 v6, 1, v6
    s_waitcnt lgkmcnt(0)
    global_load_ushort v100, v5, s[30:31]
    global_load_ushort v101, v5, s[18:19]
    global_load_ushort v102, v5, s[20:21]
    global_load_ushort v125, v6, s[32:33]
    s_mov_b32 s52, s34
    s_mov_b32 s53, s35
    s_mov_b32 s54, 1835008
    s_mov_b32 s55, 0x00020000
    s_bitcmp1_b32 s51, 0
    s_cselect_b32 s56, s40, s38
    s_cselect_b32 s57, s41, s39
    s_mov_b32 s58, 25088
    s_mov_b32 s59, 0x00020000
    s_cmp_eq_u32 s5, 3
    s_cbranch_scc1 F_A3S
    s_add_u32 s12, s15, 4
    s_sub_u32 s13, s12, 7
    s_cselect_b32 s12, s12, s13
    s_add_u32 m0, s11, 32768
    s_mul_i32 s13, s12, 3584
    s_lshl_b32 s12, s12, 7
    buffer_load_dwordx4 v12, s[52:55], s12 offen lds
    s_add_u32 m0, m0, 1024
    s_nop 0
    buffer_load_dwordx4 v13, s[52:55], s12 offen lds
    s_add_u32 m0, s10, 16384
    s_nop 0
    buffer_load_dwordx4 v16, s[56:59], s13 offen offset:0 lds
    s_add_u32 m0, m0, 128
    s_nop 0
    buffer_load_dwordx4 v16, s[56:59], s13 offen offset:896 lds
    s_add_u32 m0, m0, 128
    s_nop 0
    buffer_load_dwordx4 v16, s[56:59], s13 offen offset:1792 lds
    s_add_u32 m0, m0, 128
    s_nop 0
    buffer_load_dwordx4 v16, s[56:59], s13 offen offset:2688 lds
F_A3S:
    s_add_u32 s12, s15, 0
    s_sub_u32 s13, s12, 7
    s_cselect_b32 s12, s12, s13
    s_add_u32 m0, s11, 0
    s_mul_i32 s13, s12, 3584
    s_lshl_b32 s12, s12, 7
    buffer_load_dwordx4 v12, s[52:55], s12 offen lds
    s_add_u32 m0, m0, 1024
    s_nop 0
    buffer_load_dwordx4 v13, s[52:55], s12 offen lds
    s_add_u32 m0, s10, 0
    s_nop 0
    buffer_load_dwordx4 v16, s[56:59], s13 offen offset:0 lds
    s_add_u32 m0, m0, 128
    s_nop 0
    buffer_load_dwordx4 v16, s[56:59], s13 offen offset:896 lds
    s_add_u32 m0, m0, 128
    s_nop 0
    buffer_load_dwordx4 v16, s[56:59], s13 offen offset:1792 lds
    s_add_u32 m0, m0, 128
    s_nop 0
    buffer_load_dwordx4 v16, s[56:59], s13 offen offset:2688 lds
    s_barrier
    v_lshrrev_b32 v5, 2, v2
    v_lshl_add_u32 v5, v3, 3, v5
    v_lshlrev_b32 v5, 6, v5
    v_and_b32 v6, 1, v3
    v_lshl_add_u32 v5, v6, 5, v5
    v_and_b32 v6, 3, v2
    v_lshl_add_u32 v5, v6, 3, v5
    v_add_u32 v17, s10, v5
    v_xor_b32 v18, 32, v17
    v_lshrrev_b32 v5, 1, v2
    v_xor_b32 v5, v5, v3
    v_lshlrev_b32 v5, 4, v5
    v_lshl_add_u32 v5, v2, 7, v5
    v_add_u32 v22, s11, v5
    v_xor_b32 v23, 64, v22
    v_mov_b32 v112, 0
    v_mov_b32 v113, 0
    v_mov_b32 v114, 0
    v_mov_b32 v115, 0
    v_mov_b32 v116, 0
    v_mov_b32 v117, 0
    v_mov_b32 v118, 0
    v_mov_b32 v119, 0
    s_lshl_b32 s8, s5, 11
    s_add_u32 s8, s8, 151552
    v_add_u32 v21, s8, v4
    s_add_u32 s60, s48, 2097152
    s_addc_u32 s61, s49, 0
    s_mov_b32 s62, 262144
    s_mov_b32 s63, 0x00020000
    s_add_u32 s64, s48, 3145728
    s_addc_u32 s65, s49, 0
    s_mov_b32 s66, 147456
    s_mov_b32 s67, 0x00020000
    s_mov_b32 s68, s46
    s_mov_b32 s69, s47
    s_mov_b32 s70, 256
    s_mov_b32 s71, 0x00020000
    s_lshl_b32 s8, s50, 1
    s_lshr_b32 s9, s14, 1
    s_add_u32 s8, s8, s9
    s_lshl_b32 s8, s8, 12
    s_and_b32 s9, s14, 1
    v_mov_b32 v30, 0
    s_cmp_eq_u32 s5, 3
    s_cbranch_scc1 F_A3R
    s_waitcnt vmcnt(6)
    ds_read_b128 v[56:59], v22 offset:32768
    ds_read_b64_tr_b16 v[80:81], v17 offset:16384
    ds_read_b64_tr_b16 v[82:83], v17 offset:16640
    ds_read_b64_tr_b16 v[84:85], v18 offset:16384
    ds_read_b64_tr_b16 v[86:87], v18 offset:16640
    ds_read_b128 v[60:63], v23 offset:32768
    ds_read_b64_tr_b16 v[88:89], v17 offset:18432
    ds_read_b64_tr_b16 v[90:91], v17 offset:18688
    ds_read_b64_tr_b16 v[92:93], v18 offset:18432
    ds_read_b64_tr_b16 v[94:95], v18 offset:18688
F_A3R:
    s_waitcnt vmcnt(0)
    ds_read_b128 v[48:51], v22 offset:0
    ds_read_b64_tr_b16 v[64:65], v17 offset:0
    ds_read_b64_tr_b16 v[66:67], v17 offset:256
    ds_read_b64_tr_b16 v[68:69], v18 offset:0
    ds_read_b64_tr_b16 v[70:71], v18 offset:256
    ds_read_b128 v[52:55], v23 offset:0
    ds_read_b64_tr_b16 v[72:73], v17 offset:2048
    ds_read_b64_tr_b16 v[74:75], v17 offset:2304
    ds_read_b64_tr_b16 v[76:77], v18 offset:2048
    ds_read_b64_tr_b16 v[78:79], v18 offset:2304
    s_mov_b64 exec, 1
    ds_add_u32 v14, v15 offset:44
    s_mov_b64 exec, -1
    s_bitcmp1_b32 s51, 0
    s_cbranch_scc1 F_VM
    s_cmp_eq_u32 s5, 3
    s_cbranch_scc1 F_MS_1
    s_waitcnt lgkmcnt(11)
    v_mfma_f32_16x16x32_bf16 v[112:115], v[88:91], v[60:63], v[112:115]
    v_mfma_f32_16x16x32_bf16 v[116:119], v[92:95], v[60:63], v[116:119]
    v_mfma_f32_16x16x32_bf16 v[112:115], v[80:83], v[56:59], v[112:115]
    v_mfma_f32_16x16x32_bf16 v[116:119], v[84:87], v[56:59], v[116:119]
F_MS_1:
    s_waitcnt lgkmcnt(0)
    v_mfma_f32_16x16x32_bf16 v[112:115], v[72:75], v[52:55], v[112:115]
    v_mfma_f32_16x16x32_bf16 v[116:119], v[76:79], v[52:55], v[116:119]
    v_mfma_f32_16x16x32_bf16 v[112:115], v[64:67], v[48:51], v[112:115]
    v_mfma_f32_16x16x32_bf16 v[116:119], v[68:71], v[48:51], v[116:119]
    s_branch F_KVM
F_VM:
    s_cmp_eq_u32 s5, 3
    s_cbranch_scc1 F_MS_2
    s_waitcnt lgkmcnt(11)
    v_mfma_f32_16x16x32_bf16 v[112:115], v[60:63], v[88:91], v[112:115]
    v_mfma_f32_16x16x32_bf16 v[116:119], v[60:63], v[92:95], v[116:119]
    v_mfma_f32_16x16x32_bf16 v[112:115], v[56:59], v[80:83], v[112:115]
    v_mfma_f32_16x16x32_bf16 v[116:119], v[56:59], v[84:87], v[116:119]
F_MS_2:
    s_waitcnt lgkmcnt(0)
    v_mfma_f32_16x16x32_bf16 v[112:115], v[52:55], v[72:75], v[112:115]
    v_mfma_f32_16x16x32_bf16 v[116:119], v[52:55], v[76:79], v[116:119]
    v_mfma_f32_16x16x32_bf16 v[112:115], v[48:51], v[64:67], v[112:115]
    v_mfma_f32_16x16x32_bf16 v[116:119], v[48:51], v[68:71], v[116:119]
    s_nop 7
F_KVM:
    s_cmp_eq_u32 s5, 3
    s_cbranch_scc1 F_KVF
    ds_write_b128 v21, v[112:115]
    ds_write_b128 v21, v[116:119] offset:1024
    s_waitcnt lgkmcnt(0)
    s_mov_b64 exec, 1
    ds_add_u32 v14, v15 offset:48
    s_mov_b64 exec, -1
    s_branch F_AM
F_KVF:
    buffer_load_dword v31, v30, s[68:71], 0 offen sc1
    v_add_u32 v21, 151552, v4
    v_cmp_eq_u32 s[72:73], 3, v3
    v_cmp_le_u32 s[74:75], 12, v2
    s_mov_b32 s79, 262144
LW_3:
    ds_read_b32 v5, v14 offset:48
    s_waitcnt lgkmcnt(0)
    v_readfirstlane_b32 s78, v5
    s_nop 0
    s_cmp_ge_u32 s78, 3
    s_cbranch_scc1 LD_4
    s_sleep 0
    s_sub_u32 s79, s79, 1
    s_cmp_lg_u32 s79, 0
    s_cbranch_scc1 LW_3
LD_4:
    ds_read_b128 v[48:51], v21 offset:0
    ds_read_b128 v[52:55], v21 offset:1024
    ds_read_b128 v[56:59], v21 offset:2048
    ds_read_b128 v[60:63], v21 offset:3072
    ds_read_b128 v[64:67], v21 offset:4096
    ds_read_b128 v[68:71], v21 offset:5120
    s_lshl_b32 s12, s50, 3
    s_add_u32 s12, s12, s51
    s_lshl_b32 s12, s12, 6
    s_bitcmp1_b32 s51, 0
    s_cbranch_scc1 F_VE
    s_lshl_b32 s9, s9, 8
    s_add_u32 s8, s8, s9
    v_lshlrev_b32 v20, 9, v3
    v_lshl_add_u32 v20, v2, 4, v20
    s_mov_b32 s14, 0x3e8b97f6
    v_mov_b32 v6, 0x3f803f80
    v_mov_b32 v7, 0x00003f80
    s_waitcnt lgkmcnt(0)
    v_add_f32 v112, v112, v48
    v_add_f32 v113, v113, v49
    v_add_f32 v114, v114, v50
    v_add_f32 v115, v115, v51
    v_add_f32 v116, v116, v52
    v_add_f32 v117, v117, v53
    v_add_f32 v118, v118, v54
    v_add_f32 v119, v119, v55
    v_add_f32 v112, v112, v56
    v_add_f32 v113, v113, v57
    v_add_f32 v114, v114, v58
    v_add_f32 v115, v115, v59
    v_add_f32 v116, v116, v60
    v_add_f32 v117, v117, v61
    v_add_f32 v118, v118, v62
    v_add_f32 v119, v119, v63
    v_add_f32 v112, v112, v64
    v_add_f32 v113, v113, v65
    v_add_f32 v114, v114, v66
    v_add_f32 v115, v115, v67
    v_add_f32 v116, v116, v68
    v_add_f32 v117, v117, v69
    v_add_f32 v118, v118, v70
    v_add_f32 v119, v119, v71
    v_mul_f32 v112, s14, v112
    v_mul_f32 v113, s14, v113
    v_mul_f32 v114, s14, v114
    v_mul_f32 v115, s14, v115
    v_mul_f32 v116, s14, v116
    v_mul_f32 v117, s14, v117
    v_mul_f32 v118, s14, v118
    v_mul_f32 v119, s14, v119
    v_cvt_pk_bf16_f32 v8, v112, v113
    v_cvt_pk_bf16_f32 v9, v114, v115
    v_cvt_pk_bf16_f32 v10, v116, v117
    v_cvt_pk_bf16_f32 v11, v118, v119
    v_cndmask_b32 v10, v10, v6, s[72:73]
    v_cndmask_b32 v11, v11, v7, s[72:73]
    buffer_store_dwordx4 v[8:11], v20, s[60:63], s8 offen sc1
    s_branch F_KVPUB
    s_nop 2
F_VE:
    s_lshl_b32 s9, s9, 10
    s_add_u32 s8, s8, s9
    v_and_b32 v5, 1, v3
    v_lshlrev_b32 v5, 9, v5
    v_lshl_add_u32 v5, v2, 4, v5
    v_lshrrev_b32 v6, 1, v3
    v_lshl_add_u32 v20, v6, 3, v5
    v_cmp_eq_u32 vcc, 12, v2
    v_mov_b32 v6, 0x3f803f80
    s_nop 0
    v_cndmask_b32 v6, 0, v6, vcc
    s_waitcnt lgkmcnt(0)
    v_add_f32 v112, v112, v48
    v_add_f32 v113, v113, v49
    v_add_f32 v114, v114, v50
    v_add_f32 v115, v115, v51
    v_add_f32 v116, v116, v52
    v_add_f32 v117, v117, v53
    v_add_f32 v118, v118, v54
    v_add_f32 v119, v119, v55
    v_add_f32 v112, v112, v56
    v_add_f32 v113, v113, v57
    v_add_f32 v114, v114, v58
    v_add_f32 v115, v115, v59
    v_add_f32 v116, v116, v60
    v_add_f32 v117, v117, v61
    v_add_f32 v118, v118, v62
    v_add_f32 v119, v119, v63
    v_add_f32 v112, v112, v64
    v_add_f32 v113, v113, v65
    v_add_f32 v114, v114, v66
    v_add_f32 v115, v115, v67
    v_add_f32 v116, v116, v68
    v_add_f32 v117, v117, v69
    v_add_f32 v118, v118, v70
    v_add_f32 v119, v119, v71
    v_cvt_pk_bf16_f32 v8, v112, v113
    v_cvt_pk_bf16_f32 v9, v114, v115
    v_cvt_pk_bf16_f32 v10, v116, v117
    v_cvt_pk_bf16_f32 v11, v118, v119
    v_cndmask_b32 v10, v10, v6, s[74:75]
    v_cndmask_b32 v11, v11, v6, s[74:75]
    buffer_store_dwordx2 v[8:9], v20, s[60:63], s8 offen offset:2048 sc1
    buffer_store_dwordx2 v[10:11], v20, s[60:63], s8 offen offset:2304 sc1
    s_nop 2
F_KVPUB:
    s_mov_b32 s79, 262144
    s_waitcnt vmcnt(0)
F_NP:
    v_readfirstlane_b32 s77, v31
    s_nop 0
    s_cmp_lg_u32 s77, 0
    s_cbranch_scc1 F_NOK
    buffer_load_dword v31, v30, s[68:71], 0 offen sc1
    s_waitcnt vmcnt(0)
    s_sub_u32 s79, s79, 1
    s_cmp_lg_u32 s79, 0
    s_cbranch_scc1 F_NP
F_NOK:
    s_mov_b64 exec, 1
    buffer_store_dword v31, v30, s[64:67], s12 offen offset:0 sc1
    ds_write_b32 v14, v31 offset:28
    s_mov_b64 exec, -1
    s_branch F_AM
F_B:
    s_setprio 2
    v_lshrrev_b32 v5, 3, v1
    s_lshl_b32 s9, s3, 3
    v_add_u32 v6, s9, v5
    v_mul_u32_u24 v6, 896, v6
    v_bfe_u32 v7, v1, 1, 2
    v_bfe_u32 v5, v5, 1, 1
    v_xor_b32 v7, v7, v5
    s_and_b32 s9, s3, 1
    s_lshl_b32 s9, s9, 1
    v_xor_b32 v7, s9, v7
    v_lshrrev_b32 v5, 1, v7
    v_mul_u32_u24 v5, 56, v5
    v_add_u32 v6, v6, v5
    v_and_b32 v5, 1, v7
    v_lshl_add_u32 v6, v5, 5, v6
    v_and_b32 v5, 1, v1
    v_lshl_add_u32 v6, v5, 4, v6
    s_mul_i32 s9, s51, 112
    v_add_u32 v12, s9, v6
    s_lshl_b32 s8, s50, 6
    s_lshl_b32 s9, s3, 4
    s_add_u32 s8, s8, s9
    v_lshrrev_b32 v7, 3, v1
    v_add_u32 v7, s8, v7
    v_mul_u32_u24 v5, 896, v7
    v_and_b32 v6, 7, v1
    v_xor_b32 v6, v6, v3
    v_lshl_add_u32 v28, v6, 4, v5
    v_xor_b32 v6, 4, v6
    v_lshl_add_u32 v5, v6, 4, v5
    v_add_u32 v29, 7168, v5
    s_waitcnt lgkmcnt(0)
    s_or_b32 s8, s2, s3
    s_cmp_lg_u32 s8, 0
    s_cbranch_scc1 F_NN
    s_mov_b32 s68, s46
    s_mov_b32 s69, s47
    s_mov_b32 s70, 256
    s_mov_b32 s71, 0x00020000
    s_or_b32 s8, s6, 1
    v_mov_b32 v5, s8
    v_mov_b32 v6, 0
    buffer_store_dword v5, v6, s[68:71], 0 offen sc1
    s_nop 3
F_NN:
    s_mov_b32 s52, s36
    s_mov_b32 s53, s37
    s_mov_b32 s54, 401408
    s_mov_b32 s55, 0x00020000
    s_mov_b32 s56, s34
    s_mov_b32 s57, s35
    s_mov_b32 s58, 1835008
    s_mov_b32 s59, 0x00020000
    s_lshl_b32 s12, s76, 7
    s_lshl_b32 s10, s3, 10
    s_lshl_b32 s11, s3, 11
    s_barrier
    s_add_u32 m0, s11, 86016
    s_mul_i32 s13, s12, 448
    buffer_load_dwordx4 v28, s[56:59], s12 offen lds
    s_add_u32 m0, m0, 1024
    s_nop 0
    buffer_load_dwordx4 v29, s[56:59], s12 offen lds
    s_add_u32 m0, s10, 0
    s_add_u32 s12, s12, 128
    s_cmp_ge_u32 s12, 896
    s_cselect_b32 s12, 0, s12
    buffer_load_dwordx4 v12, s[52:55], s13 offen lds
    s_add_u32 m0, m0, 4096
    s_add_u32 s13, s13, 28672
    buffer_load_dwordx4 v12, s[52:55], s13 offen lds
    s_add_u32 m0, s11, 94208
    s_mul_i32 s13, s12, 448
    buffer_load_dwordx4 v28, s[56:59], s12 offen lds
    s_add_u32 m0, m0, 1024
    s_nop 0
    buffer_load_dwordx4 v29, s[56:59], s12 offen lds
    s_add_u32 m0, s10, 8192
    s_add_u32 s12, s12, 128
    s_cmp_ge_u32 s12, 896
    s_cselect_b32 s12, 0, s12
    buffer_load_dwordx4 v12, s[52:55], s13 offen lds
    s_add_u32 m0, m0, 4096
    s_add_u32 s13, s13, 28672
    buffer_load_dwordx4 v12, s[52:55], s13 offen lds
    s_add_u32 m0, s11, 102400
    s_mul_i32 s13, s12, 448
    buffer_load_dwordx4 v28, s[56:59], s12 offen lds
    s_add_u32 m0, m0, 1024
    s_nop 0
    buffer_load_dwordx4 v29, s[56:59], s12 offen lds
    s_add_u32 m0, s10, 16384
    s_add_u32 s12, s12, 128
    s_cmp_ge_u32 s12, 896
    s_cselect_b32 s12, 0, s12
    buffer_load_dwordx4 v12, s[52:55], s13 offen lds
    s_add_u32 m0, m0, 4096
    s_add_u32 s13, s13, 28672
    buffer_load_dwordx4 v12, s[52:55], s13 offen lds
    s_add_u32 m0, s11, 110592
    s_mul_i32 s13, s12, 448
    buffer_load_dwordx4 v28, s[56:59], s12 offen lds
    s_add_u32 m0, m0, 1024
    s_nop 0
    buffer_load_dwordx4 v29, s[56:59], s12 offen lds
    s_add_u32 m0, s10, 24576
    s_add_u32 s12, s12, 128
    s_cmp_ge_u32 s12, 896
    s_cselect_b32 s12, 0, s12
    buffer_load_dwordx4 v12, s[52:55], s13 offen lds
    s_add_u32 m0, m0, 4096
    s_add_u32 s13, s13, 28672
    buffer_load_dwordx4 v12, s[52:55], s13 offen lds
    s_add_u32 s64, s48, 3145728
    s_addc_u32 s65, s49, 0
    s_mov_b32 s66, 147456
    s_mov_b32 s67, 0x00020000
    v_cmp_eq_u32 s[72:73], 3, v3
    v_lshrrev_b32 v5, 2, v2
    v_lshl_add_u32 v5, v3, 3, v5
    v_lshlrev_b32 v5, 7, v5
    v_lshrrev_b32 v6, 3, v2
    v_lshl_add_u32 v5, v6, 5, v5
    v_and_b32 v6, 1, v3
    v_lshl_add_u32 v5, v6, 6, v5
    v_and_b32 v6, 3, v2
    v_lshl_add_u32 v5, v6, 3, v5
    s_and_b32 s9, s3, 1
    s_lshl_b32 s9, s9, 6
    v_xor_b32 v16, s9, v5
    v_xor_b32 v17, 32, v16
    s_lshr_b32 s8, s3, 1
    s_lshl_b32 s8, s8, 12
    s_add_u32 s8, s8, 86016
    v_lshrrev_b32 v5, 1, v2
    v_xor_b32 v5, v5, v3
    v_lshlrev_b32 v5, 4, v5
    v_lshl_add_u32 v5, v2, 7, v5
    v_add_u32 v18, s8, v5
    v_xor_b32 v19, 64, v18
    s_lshl_b32 s8, s3, 11
    s_add_u32 s8, s8, 143360
    v_lshlrev_b32 v5, 9, v3
    v_lshl_add_u32 v5, v2, 4, v5
    v_add_u32 v13, s8, v5
    v_lshlrev_b32 v30, 6, v1
    s_lshl_b32 s8, s3, 12
    s_waitcnt vmcnt(8)
    s_mov_b64 exec, 1
    ds_add_u32 v14, v15 offset:0
    s_mov_b64 exec, -1
    s_mov_b32 s79, 262144
LW_5:
    ds_read_b32 v5, v14 offset:0
    s_waitcnt lgkmcnt(0)
    v_readfirstlane_b32 s78, v5
    s_nop 0
    s_cmp_ge_u32 s78, 4
    s_cbranch_scc1 LD_6
    s_sleep 0
    s_sub_u32 s79, s79, 1
    s_cmp_lg_u32 s79, 0
    s_cbranch_scc1 LW_5
LD_6:
    ds_read_b128 v[48:51], v18 offset:0
    ds_read_b128 v[52:55], v18 offset:2048
    ds_read_b64_tr_b16 v[80:81], v16 offset:0
    ds_read_b64_tr_b16 v[82:83], v16 offset:512
    ds_read_b64_tr_b16 v[84:85], v17 offset:0
    ds_read_b64_tr_b16 v[86:87], v17 offset:512
    ds_read_b128 v[56:59], v19 offset:0
    ds_read_b128 v[60:63], v19 offset:2048
    ds_read_b64_tr_b16 v[88:89], v16 offset:4096
    ds_read_b64_tr_b16 v[90:91], v16 offset:4608
    ds_read_b64_tr_b16 v[92:93], v17 offset:4096
    ds_read_b64_tr_b16 v[94:95], v17 offset:4608
    ds_read_b128 v[64:67], v18 offset:8192
    ds_read_b128 v[68:71], v18 offset:10240
    ds_read_b64_tr_b16 v[96:97], v16 offset:8192
    ds_read_b64_tr_b16 v[98:99], v16 offset:8704
    ds_read_b64_tr_b16 v[100:101], v17 offset:8192
    ds_read_b64_tr_b16 v[102:103], v17 offset:8704
    s_waitcnt lgkmcnt(12)
    v_mfma_f32_16x16x32_bf16 v[112:115], v[80:83], v[48:51], 0
    v_mfma_f32_16x16x32_bf16 v[116:119], v[84:87], v[48:51], 0
    v_mfma_f32_16x16x32_bf16 v[120:123], v[80:83], v[52:55], 0
    v_mfma_f32_16x16x32_bf16 v[124:127], v[84:87], v[52:55], 0
    ds_read_b128 v[48:51], v19 offset:8192
    ds_read_b128 v[52:55], v19 offset:10240
    ds_read_b64_tr_b16 v[80:81], v16 offset:12288
    ds_read_b64_tr_b16 v[82:83], v16 offset:12800
    ds_read_b64_tr_b16 v[84:85], v17 offset:12288
    ds_read_b64_tr_b16 v[86:87], v17 offset:12800
    s_waitcnt lgkmcnt(12)
    v_mfma_f32_16x16x32_bf16 v[112:115], v[88:91], v[56:59], v[112:115]
    v_mfma_f32_16x16x32_bf16 v[116:119], v[92:95], v[56:59], v[116:119]
    v_mfma_f32_16x16x32_bf16 v[120:123], v[88:91], v[60:63], v[120:123]
    v_mfma_f32_16x16x32_bf16 v[124:127], v[92:95], v[60:63], v[124:127]
    s_add_u32 m0, s11, 118784
    s_mul_i32 s13, s12, 448
    buffer_load_dwordx4 v28, s[56:59], s12 offen lds
    s_add_u32 m0, m0, 1024
    s_nop 0
    buffer_load_dwordx4 v29, s[56:59], s12 offen lds
    s_add_u32 m0, s10, 32768
    s_add_u32 s12, s12, 128
    s_cmp_ge_u32 s12, 896
    s_cselect_b32 s12, 0, s12
    buffer_load_dwordx4 v12, s[52:55], s13 offen lds
    s_add_u32 m0, m0, 4096
    s_add_u32 s13, s13, 28672
    buffer_load_dwordx4 v12, s[52:55], s13 offen lds
    s_add_u32 m0, s11, 126976
    s_mul_i32 s13, s12, 448
    buffer_load_dwordx4 v28, s[56:59], s12 offen lds
    s_add_u32 m0, m0, 1024
    s_nop 0
    buffer_load_dwordx4 v29, s[56:59], s12 offen lds
    s_add_u32 m0, s10, 40960
    s_add_u32 s12, s12, 128
    s_cmp_ge_u32 s12, 896
    s_cselect_b32 s12, 0, s12
    buffer_load_dwordx4 v12, s[52:55], s13 offen lds
    s_add_u32 m0, m0, 4096
    s_add_u32 s13, s13, 28672
    buffer_load_dwordx4 v12, s[52:55], s13 offen lds
    s_waitcnt lgkmcnt(6)
    v_mfma_f32_16x16x32_bf16 v[112:115], v[96:99], v[64:67], v[112:115]
    v_mfma_f32_16x16x32_bf16 v[116:119], v[100:103], v[64:67], v[116:119]
    v_mfma_f32_16x16x32_bf16 v[120:123], v[96:99], v[68:71], v[120:123]
    v_mfma_f32_16x16x32_bf16 v[124:127], v[100:103], v[68:71], v[124:127]
    s_waitcnt lgkmcnt(0)
    v_mfma_f32_16x16x32_bf16 v[112:115], v[80:83], v[48:51], v[112:115]
    v_mfma_f32_16x16x32_bf16 v[116:119], v[84:87], v[48:51], v[116:119]
    v_mfma_f32_16x16x32_bf16 v[120:123], v[80:83], v[52:55], v[120:123]
    v_mfma_f32_16x16x32_bf16 v[124:127], v[84:87], v[52:55], v[124:127]
    s_waitcnt vmcnt(8)
    v_nop
    v_nop
    s_mov_b64 exec, 1
    ds_add_u32 v14, v15 offset:4
    s_mov_b64 exec, -1
    s_mov_b32 s79, 262144
LW_7:
    ds_read_b32 v5, v14 offset:4
    s_waitcnt lgkmcnt(0)
    v_readfirstlane_b32 s78, v5
    s_nop 0
    s_cmp_ge_u32 s78, 4
    s_cbranch_scc1 LD_8
    s_sleep 0
    s_sub_u32 s79, s79, 1
    s_cmp_lg_u32 s79, 0
    s_cbranch_scc1 LW_7
LD_8:
    s_add_u32 m0, s11, 135168
    s_mul_i32 s13, s12, 448
    buffer_load_dwordx4 v28, s[56:59], s12 offen lds
    s_add_u32 m0, m0, 1024
    s_nop 0
    buffer_load_dwordx4 v29, s[56:59], s12 offen lds
    s_add_u32 m0, s10, 49152
    s_nop 0
    buffer_load_dwordx4 v12, s[52:55], s13 offen lds
    s_add_u32 m0, m0, 4096
    s_add_u32 s13, s13, 28672
    buffer_load_dwordx4 v12, s[52:55], s13 offen lds
    ds_read_b128 v[56:59], v18 offset:16384
    ds_read_b128 v[60:63], v18 offset:18432
    ds_read_b64_tr_b16 v[88:89], v16 offset:16384
    ds_read_b64_tr_b16 v[90:91], v16 offset:16896
    ds_read_b64_tr_b16 v[92:93], v17 offset:16384
    ds_read_b64_tr_b16 v[94:95], v17 offset:16896
    ds_read_b128 v[64:67], v19 offset:16384
    ds_read_b128 v[68:71], v19 offset:18432
    ds_read_b64_tr_b16 v[96:97], v16 offset:20480
    ds_read_b64_tr_b16 v[98:99], v16 offset:20992
    ds_read_b64_tr_b16 v[100:101], v17 offset:20480
    ds_read_b64_tr_b16 v[102:103], v17 offset:20992
    ds_read_b128 v[48:51], v18 offset:24576
    ds_read_b128 v[52:55], v18 offset:26624
    ds_read_b64_tr_b16 v[80:81], v16 offset:24576
    ds_read_b64_tr_b16 v[82:83], v16 offset:25088
    ds_read_b64_tr_b16 v[84:85], v17 offset:24576
    ds_read_b64_tr_b16 v[86:87], v17 offset:25088
    s_waitcnt lgkmcnt(12)
    v_mfma_f32_16x16x32_bf16 v[112:115], v[88:91], v[56:59], v[112:115]
    v_mfma_f32_16x16x32_bf16 v[116:119], v[92:95], v[56:59], v[116:119]
    v_mfma_f32_16x16x32_bf16 v[120:123], v[88:91], v[60:63], v[120:123]
    v_mfma_f32_16x16x32_bf16 v[124:127], v[92:95], v[60:63], v[124:127]
    ds_read_b128 v[56:59], v19 offset:24576
    ds_read_b128 v[60:63], v19 offset:26624
    ds_read_b64_tr_b16 v[88:89], v16 offset:28672
    ds_read_b64_tr_b16 v[90:91], v16 offset:29184
    ds_read_b64_tr_b16 v[92:93], v17 offset:28672
    ds_read_b64_tr_b16 v[94:95], v17 offset:29184
    s_waitcnt lgkmcnt(12)
    v_mfma_f32_16x16x32_bf16 v[112:115], v[96:99], v[64:67], v[112:115]
    v_mfma_f32_16x16x32_bf16 v[116:119], v[100:103], v[64:67], v[116:119]
    v_mfma_f32_16x16x32_bf16 v[120:123], v[96:99], v[68:71], v[120:123]
    v_mfma_f32_16x16x32_bf16 v[124:127], v[100:103], v[68:71], v[124:127]
    s_waitcnt lgkmcnt(6)
    v_mfma_f32_16x16x32_bf16 v[112:115], v[80:83], v[48:51], v[112:115]
    v_mfma_f32_16x16x32_bf16 v[116:119], v[84:87], v[48:51], v[116:119]
    v_mfma_f32_16x16x32_bf16 v[120:123], v[80:83], v[52:55], v[120:123]
    v_mfma_f32_16x16x32_bf16 v[124:127], v[84:87], v[52:55], v[124:127]
    s_waitcnt lgkmcnt(0)
    v_mfma_f32_16x16x32_bf16 v[112:115], v[88:91], v[56:59], v[112:115]
    v_mfma_f32_16x16x32_bf16 v[116:119], v[92:95], v[56:59], v[116:119]
    v_mfma_f32_16x16x32_bf16 v[120:123], v[88:91], v[60:63], v[120:123]
    v_mfma_f32_16x16x32_bf16 v[124:127], v[92:95], v[60:63], v[124:127]
    s_waitcnt vmcnt(0)
    v_nop
    v_nop
    s_mov_b64 exec, 1
    ds_add_u32 v14, v15 offset:8
    s_mov_b64 exec, -1
    s_mov_b32 s79, 262144
LW_9:
    ds_read_b32 v5, v14 offset:8
    s_waitcnt lgkmcnt(0)
    v_readfirstlane_b32 s78, v5
    s_nop 0
    s_cmp_ge_u32 s78, 4
    s_cbranch_scc1 LD_10
    s_sleep 0
    s_sub_u32 s79, s79, 1
    s_cmp_lg_u32 s79, 0
    s_cbranch_scc1 LW_9
LD_10:
    ds_read_b128 v[64:67], v18 offset:32768
    ds_read_b128 v[68:71], v18 offset:34816
    ds_read_b64_tr_b16 v[96:97], v16 offset:32768
    ds_read_b64_tr_b16 v[98:99], v16 offset:33280
    ds_read_b64_tr_b16 v[100:101], v17 offset:32768
    ds_read_b64_tr_b16 v[102:103], v17 offset:33280
    ds_read_b128 v[48:51], v19 offset:32768
    ds_read_b128 v[52:55], v19 offset:34816
    ds_read_b64_tr_b16 v[80:81], v16 offset:36864
    ds_read_b64_tr_b16 v[82:83], v16 offset:37376
    ds_read_b64_tr_b16 v[84:85], v17 offset:36864
    ds_read_b64_tr_b16 v[86:87], v17 offset:37376
    ds_read_b128 v[56:59], v18 offset:40960
    ds_read_b128 v[60:63], v18 offset:43008
    ds_read_b64_tr_b16 v[88:89], v16 offset:40960
    ds_read_b64_tr_b16 v[90:91], v16 offset:41472
    ds_read_b64_tr_b16 v[92:93], v17 offset:40960
    ds_read_b64_tr_b16 v[94:95], v17 offset:41472
    s_waitcnt lgkmcnt(12)
    v_mfma_f32_16x16x32_bf16 v[112:115], v[96:99], v[64:67], v[112:115]
    v_mfma_f32_16x16x32_bf16 v[116:119], v[100:103], v[64:67], v[116:119]
    v_mfma_f32_16x16x32_bf16 v[120:123], v[96:99], v[68:71], v[120:123]
    v_mfma_f32_16x16x32_bf16 v[124:127], v[100:103], v[68:71], v[124:127]
    ds_read_b128 v[64:67], v19 offset:40960
    ds_read_b128 v[68:71], v19 offset:43008
    ds_read_b64_tr_b16 v[96:97], v16 offset:45056
    ds_read_b64_tr_b16 v[98:99], v16 offset:45568
    ds_read_b64_tr_b16 v[100:101], v17 offset:45056
    ds_read_b64_tr_b16 v[102:103], v17 offset:45568
    s_waitcnt lgkmcnt(12)
    v_mfma_f32_16x16x32_bf16 v[112:115], v[80:83], v[48:51], v[112:115]
    v_mfma_f32_16x16x32_bf16 v[116:119], v[84:87], v[48:51], v[116:119]
    v_mfma_f32_16x16x32_bf16 v[120:123], v[80:83], v[52:55], v[120:123]
    v_mfma_f32_16x16x32_bf16 v[124:127], v[84:87], v[52:55], v[124:127]
    ds_read_b128 v[48:51], v18 offset:49152
    ds_read_b128 v[52:55], v18 offset:51200
    ds_read_b64_tr_b16 v[80:81], v16 offset:49152
    ds_read_b64_tr_b16 v[82:83], v16 offset:49664
    ds_read_b64_tr_b16 v[84:85], v17 offset:49152
    ds_read_b64_tr_b16 v[86:87], v17 offset:49664
    s_waitcnt lgkmcnt(12)
    v_mfma_f32_16x16x32_bf16 v[112:115], v[88:91], v[56:59], v[112:115]
    v_mfma_f32_16x16x32_bf16 v[116:119], v[92:95], v[56:59], v[116:119]
    v_mfma_f32_16x16x32_bf16 v[120:123], v[88:91], v[60:63], v[120:123]
    v_mfma_f32_16x16x32_bf16 v[124:127], v[92:95], v[60:63], v[124:127]
    ds_read_b128 v[56:59], v19 offset:49152
    ds_read_b128 v[60:63], v19 offset:51200
    ds_read_b64_tr_b16 v[88:89], v16 offset:53248
    ds_read_b64_tr_b16 v[90:91], v16 offset:53760
    ds_read_b64_tr_b16 v[92:93], v17 offset:53248
    ds_read_b64_tr_b16 v[94:95], v17 offset:53760
    s_waitcnt lgkmcnt(12)
    v_mfma_f32_16x16x32_bf16 v[112:115], v[96:99], v[64:67], v[112:115]
    v_mfma_f32_16x16x32_bf16 v[116:119], v[100:103], v[64:67], v[116:119]
    v_mfma_f32_16x16x32_bf16 v[120:123], v[96:99], v[68:71], v[120:123]
    v_mfma_f32_16x16x32_bf16 v[124:127], v[100:103], v[68:71], v[124:127]
    s_waitcnt lgkmcnt(6)
    v_mfma_f32_16x16x32_bf16 v[112:115], v[80:83], v[48:51], v[112:115]
    v_mfma_f32_16x16x32_bf16 v[116:119], v[84:87], v[48:51], v[116:119]
    v_mfma_f32_16x16x32_bf16 v[120:123], v[80:83], v[52:55], v[120:123]
    v_mfma_f32_16x16x32_bf16 v[124:127], v[84:87], v[52:55], v[124:127]
    s_waitcnt lgkmcnt(0)
    v_mfma_f32_16x16x32_bf16 v[112:115], v[88:91], v[56:59], v[112:115]
    v_mfma_f32_16x16x32_bf16 v[116:119], v[92:95], v[56:59], v[116:119]
    v_mfma_f32_16x16x32_bf16 v[120:123], v[88:91], v[60:63], v[120:123]
    v_mfma_f32_16x16x32_bf16 v[124:127], v[92:95], v[60:63], v[124:127]
    s_lshl_b32 s13, s3, 16
    s_add_u32 s56, s48, s13
    s_addc_u32 s57, s49, 0
    s_add_u32 s56, s56, 2097152
    s_addc_u32 s57, s57, 0
    s_mov_b32 s58, 65536
    s_mov_b32 s59, 0x00020000
    s_mov_b32 s79, 262144
LW_11:
    ds_read_b32 v5, v14 offset:28
    s_waitcnt lgkmcnt(0)
    v_readfirstlane_b32 s77, v5
    s_nop 0
    s_cmp_lg_u32 s77, 0
    s_cbranch_scc1 LD_12
    s_sleep 1
    s_sub_u32 s79, s79, 1
    s_cmp_lg_u32 s79, 0
    s_cbranch_scc1 LW_11
LD_12:
    buffer_load_dword v7, v30, s[64:67], s8 offen sc1
    s_mov_b32 s9, 0
    v_mov_b32 v6, v30
    v_cvt_pk_bf16_f32 v20, v112, v113
    v_cvt_pk_bf16_f32 v21, v114, v115
    v_cvt_pk_bf16_f32 v22, v116, v117
    v_cvt_pk_bf16_f32 v23, v118, v119
    v_cndmask_b32 v22, v22, 0, s[72:73]
    v_cndmask_b32 v23, v23, 0, s[72:73]
    ds_write_b128 v13, v[20:23] offset:0
    v_cvt_pk_bf16_f32 v24, v120, v121
    v_cvt_pk_bf16_f32 v25, v122, v123
    v_cvt_pk_bf16_f32 v26, v124, v125
    v_cvt_pk_bf16_f32 v27, v126, v127
    v_cndmask_b32 v26, v26, 0, s[72:73]
    v_cndmask_b32 v27, v27, 0, s[72:73]
    ds_write_b128 v13, v[24:27] offset:256
    s_waitcnt lgkmcnt(0)
    s_mov_b64 exec, 1
    ds_add_u32 v14, v15 offset:12
    s_mov_b64 exec, -1
    s_add_u32 s60, s48, 4194304
    s_addc_u32 s61, s49, 0
    s_mov_b32 s62, 2097152
    s_mov_b32 s63, 0x00020000
    v_mov_b32 v48, 0
    v_mov_b32 v49, 0
    v_mov_b32 v50, 0
    v_mov_b32 v51, 0
    v_mov_b32 v52, 0
    v_mov_b32 v53, 0
    v_mov_b32 v54, 0
    v_mov_b32 v55, 0
    v_mov_b32 v56, 0
    v_mov_b32 v57, 0
    v_mov_b32 v58, 0
    v_mov_b32 v59, 0
    v_mov_b32 v60, 0
    v_mov_b32 v61, 0
    v_mov_b32 v62, 0
    v_mov_b32 v63, 0
    v_mov_b32 v64, 0
    v_mov_b32 v65, 0
    v_mov_b32 v66, 0
    v_mov_b32 v67, 0
    v_mov_b32 v68, 0
    v_mov_b32 v69, 0
    v_mov_b32 v70, 0
    v_mov_b32 v71, 0
    v_mov_b32 v72, 0
    v_mov_b32 v73, 0
    v_mov_b32 v74, 0
    v_mov_b32 v75, 0
    v_mov_b32 v76, 0
    v_mov_b32 v77, 0
    v_mov_b32 v78, 0
    v_mov_b32 v79, 0
    v_mov_b32 v80, 0
    v_mov_b32 v81, 0
    v_mov_b32 v82, 0
    v_mov_b32 v83, 0
    v_mov_b32 v84, 0
    v_mov_b32 v85, 0
    v_mov_b32 v86, 0
    v_mov_b32 v87, 0
    v_mov_b32 v88, 0
    v_mov_b32 v89, 0
    v_mov_b32 v90, 0
    v_mov_b32 v91, 0
    v_mov_b32 v92, 0
    v_mov_b32 v93, 0
    v_mov_b32 v94, 0
    v_mov_b32 v95, 0
    v_mov_b32 v96, 0
    v_mov_b32 v97, 0
    v_mov_b32 v98, 0
    v_mov_b32 v99, 0
    v_mov_b32 v100, 0
    v_mov_b32 v101, 0
    v_mov_b32 v102, 0
    v_mov_b32 v103, 0
    v_mov_b32 v104, 0
    v_mov_b32 v105, 0
    v_mov_b32 v106, 0
    v_mov_b32 v107, 0
    v_mov_b32 v108, 0
    v_mov_b32 v109, 0
    v_mov_b32 v110, 0
    v_mov_b32 v111, 0
    v_mov_b32 v212, 0
    v_mov_b32 v148, 0
    v_mov_b32 v213, 0
    v_mov_b32 v149, 0
    v_mov_b32 v214, 0
    v_mov_b32 v150, 0
    v_mov_b32 v215, 0
    v_mov_b32 v151, 0
    s_add_u32 s68, s3, 1
    s_and_b32 s68, s68, 3
    s_add_u32 s69, s3, 2
    s_and_b32 s69, s69, 3
    s_add_u32 s70, s3, 3
    s_and_b32 s70, s70, 3
    s_add_u32 s71, s3, 4
    s_and_b32 s71, s71, 3
    v_cmp_le_u32 s[74:75], 32, v1
    s_mov_b32 s79, 262144
LW_13:
    ds_read_b32 v5, v14 offset:12
    s_waitcnt lgkmcnt(0)
    v_readfirstlane_b32 s78, v5
    s_nop 0
    s_cmp_ge_u32 s78, 4
    s_cbranch_scc1 LD_14
    s_sleep 0
    s_sub_u32 s79, s79, 1
    s_cmp_lg_u32 s79, 0
    s_cbranch_scc1 LW_13
LD_14:
    s_lshl_b32 s14, s68, 11
    s_add_u32 s14, s14, 143360
    v_add_u32 v13, s14, v4
    ds_read_b128 v[16:19], v13
    ds_read_b128 v[20:23], v13 offset:1024
    s_lshl_b32 s14, s69, 11
    s_add_u32 s14, s14, 143360
    v_add_u32 v13, s14, v4
    ds_read_b128 v[24:27], v13
    ds_read_b128 v[28:31], v13 offset:1024
    s_lshl_b32 s14, s70, 11
    s_add_u32 s14, s14, 143360
    v_add_u32 v13, s14, v4
    ds_read_b128 v[32:35], v13
    ds_read_b128 v[36:39], v13 offset:1024
    s_lshl_b32 s14, s71, 11
    s_add_u32 s14, s14, 143360
    v_add_u32 v13, s14, v4
    ds_read_b128 v[40:43], v13
    ds_read_b128 v[44:47], v13 offset:1024
    s_mov_b32 s4, 4
    s_cmp_eq_u32 s9, 1
    s_cbranch_scc1 F_GO
    s_waitcnt vmcnt(0)
    v_cmp_ne_u32 vcc, s77, v7
    s_nop 0
    s_cbranch_vccz F_KVOK
    s_mov_b32 s79, 262144
PW_15:
    buffer_load_dword v5, v6, s[64:67], s8 offen sc1
    s_waitcnt vmcnt(0)
    v_cmp_ne_u32 vcc, s77, v5
    s_nop 0
    s_cbranch_vccz PD_16
    s_sleep 2
    s_sub_u32 s79, s79, 1
    s_cmp_lg_u32 s79, 0
    s_cbranch_scc1 PW_15
PD_16:
F_KVOK:
    s_lshl_b32 s15, s2, 9
    s_and_b32 s15, s15, 0xf000
    buffer_load_dwordx4 v[152:155], v4, s[56:59], s15 offen sc1
    buffer_load_dwordx4 v[156:159], v4, s[56:59], s15 offen offset:1024 sc1
    buffer_load_dwordx4 v[160:163], v4, s[56:59], s15 offen offset:2048 sc1
    buffer_load_dwordx4 v[164:167], v4, s[56:59], s15 offen offset:3072 sc1
    s_add_u32 s15, s15, 4096
    s_and_b32 s15, s15, 0xffff
    buffer_load_dwordx4 v[168:171], v4, s[56:59], s15 offen sc1
    buffer_load_dwordx4 v[172:175], v4, s[56:59], s15 offen offset:1024 sc1
    buffer_load_dwordx4 v[176:179], v4, s[56:59], s15 offen offset:2048 sc1
    buffer_load_dwordx4 v[180:183], v4, s[56:59], s15 offen offset:3072 sc1
    s_add_u32 s15, s15, 4096
    s_and_b32 s15, s15, 0xffff
    buffer_load_dwordx4 v[184:187], v4, s[56:59], s15 offen sc1
    buffer_load_dwordx4 v[188:191], v4, s[56:59], s15 offen offset:1024 sc1
    buffer_load_dwordx4 v[192:195], v4, s[56:59], s15 offen offset:2048 sc1
    buffer_load_dwordx4 v[196:199], v4, s[56:59], s15 offen offset:3072 sc1
    s_add_u32 s15, s15, 4096
    s_and_b32 s15, s15, 0xffff
    buffer_load_dwordx4 v[200:203], v4, s[56:59], s15 offen sc1
    buffer_load_dwordx4 v[204:207], v4, s[56:59], s15 offen offset:1024 sc1
F_GO:
    s_waitcnt lgkmcnt(0)
    s_mov_b64 exec, 1
    ds_add_u32 v14, v15 offset:20
    s_mov_b64 exec, -1
F_RESTART:
    s_waitcnt vmcnt(10)
    v_mfma_f32_32x32x16_bf16 v[112:127], v[152:155], v[16:19], 0
    v_mfma_f32_32x32x16_bf16 v[112:127], v[156:159], v[20:23], v[112:127]
    s_mov_b32 s14, 4
    s_setprio 0
    s_nop 9
.p2align 6
F_LOOP:
    v_mfma_f32_32x32x16_bf16 v[128:143], v[152:155], v[24:27], 0
    s_setprio 2
    v_exp_f32 v112, v112
    v_exp_f32 v113, v113
    v_exp_f32 v114, v114
    v_exp_f32 v115, v115
    v_cvt_pk_bf16_f32 v144, v112, v113
    v_cvt_pk_bf16_f32 v145, v114, v115
    v_mfma_f32_32x32x16_bf16 v[128:143], v[156:159], v[28:31], v[128:143]
    buffer_load_dwordx4 v[208:211], v4, s[56:59], s15 offen offset:2048 sc1
    v_exp_f32 v116, v116
    v_exp_f32 v117, v117
    v_exp_f32 v118, v118
    v_exp_f32 v119, v119
    v_cvt_pk_bf16_f32 v146, v116, v117
    v_cvt_pk_bf16_f32 v147, v118, v119
    v_mfma_f32_32x32x16_bf16 v[96:111], v[212:215], v[148:151], v[96:111]
    buffer_load_dwordx4 v[212:215], v4, s[56:59], s15 offen offset:3072 sc1
    v_exp_f32 v120, v120
    v_exp_f32 v121, v121
    v_exp_f32 v122, v122
    v_exp_f32 v123, v123
    v_cvt_pk_bf16_f32 v148, v120, v121
    v_cvt_pk_bf16_f32 v149, v122, v123
    v_mfma_f32_32x32x16_bf16 v[48:63], v[160:163], v[144:147], v[48:63]
    s_setprio 0
    v_exp_f32 v124, v124
    v_exp_f32 v125, v125
    v_exp_f32 v126, v126
    v_exp_f32 v127, v127
    v_cvt_pk_bf16_f32 v150, v124, v125
    v_cvt_pk_bf16_f32 v151, v126, v127
    v_mfma_f32_32x32x16_bf16 v[112:127], v[152:155], v[32:35], 0
    s_add_u32 s15, s15, 4096
    v_exp_f32 v128, v128
    v_exp_f32 v129, v129
    v_exp_f32 v130, v130
    v_exp_f32 v131, v131
    v_cvt_pk_bf16_f32 v144, v128, v129
    v_cvt_pk_bf16_f32 v145, v130, v131
    v_mfma_f32_32x32x16_bf16 v[112:127], v[156:159], v[36:39], v[112:127]
    s_and_b32 s15, s15, 0xffff
    v_exp_f32 v132, v132
    v_exp_f32 v133, v133
    v_exp_f32 v134, v134
    v_exp_f32 v135, v135
    v_cvt_pk_bf16_f32 v146, v132, v133
    v_cvt_pk_bf16_f32 v147, v134, v135
    v_mfma_f32_32x32x16_bf16 v[48:63], v[164:167], v[148:151], v[48:63]
    s_cmp_eq_u32 s14, 1
    v_exp_f32 v136, v136
    v_exp_f32 v137, v137
    v_exp_f32 v138, v138
    v_exp_f32 v139, v139
    v_cvt_pk_bf16_f32 v148, v136, v137
    v_cvt_pk_bf16_f32 v149, v138, v139
    v_mfma_f32_32x32x16_bf16 v[64:79], v[160:163], v[144:147], v[64:79]
    s_cselect_b32 s58, 0, s58
    v_exp_f32 v140, v140
    v_exp_f32 v141, v141
    v_exp_f32 v142, v142
    v_exp_f32 v143, v143
    v_cvt_pk_bf16_f32 v150, v140, v141
    v_cvt_pk_bf16_f32 v151, v142, v143
    v_mfma_f32_32x32x16_bf16 v[128:143], v[152:155], v[40:43], 0
    buffer_load_dwordx4 v[152:155], v4, s[56:59], s15 offen offset:0 sc1
    v_exp_f32 v112, v112
    v_exp_f32 v113, v113
    v_exp_f32 v114, v114
    v_exp_f32 v115, v115
    v_cvt_pk_bf16_f32 v144, v112, v113
    v_cvt_pk_bf16_f32 v145, v114, v115
    v_mfma_f32_32x32x16_bf16 v[128:143], v[156:159], v[44:47], v[128:143]
    buffer_load_dwordx4 v[156:159], v4, s[56:59], s15 offen offset:1024 sc1
    v_exp_f32 v116, v116
    v_exp_f32 v117, v117
    v_exp_f32 v118, v118
    v_exp_f32 v119, v119
    v_cvt_pk_bf16_f32 v146, v116, v117
    v_cvt_pk_bf16_f32 v147, v118, v119
    v_mfma_f32_32x32x16_bf16 v[64:79], v[164:167], v[148:151], v[64:79]
    s_setprio 0
    v_exp_f32 v120, v120
    v_exp_f32 v121, v121
    v_exp_f32 v122, v122
    v_exp_f32 v123, v123
    v_cvt_pk_bf16_f32 v148, v120, v121
    v_cvt_pk_bf16_f32 v149, v122, v123
    v_mfma_f32_32x32x16_bf16 v[80:95], v[160:163], v[144:147], v[80:95]
    s_waitcnt vmcnt(10)
    v_exp_f32 v124, v124
    v_exp_f32 v125, v125
    v_exp_f32 v126, v126
    v_exp_f32 v127, v127
    v_cvt_pk_bf16_f32 v150, v124, v125
    v_cvt_pk_bf16_f32 v151, v126, v127
    v_mfma_f32_32x32x16_bf16 v[112:127], v[168:171], v[16:19], 0
    v_exp_f32 v128, v128
    v_exp_f32 v129, v129
    v_exp_f32 v130, v130
    v_exp_f32 v131, v131
    v_cvt_pk_bf16_f32 v144, v128, v129
    v_cvt_pk_bf16_f32 v145, v130, v131
    v_mfma_f32_32x32x16_bf16 v[112:127], v[172:175], v[20:23], v[112:127]
    v_exp_f32 v132, v132
    v_exp_f32 v133, v133
    v_exp_f32 v134, v134
    v_exp_f32 v135, v135
    v_cvt_pk_bf16_f32 v146, v132, v133
    v_cvt_pk_bf16_f32 v147, v134, v135
    v_mfma_f32_32x32x16_bf16 v[80:95], v[164:167], v[148:151], v[80:95]
    v_exp_f32 v136, v136
    v_exp_f32 v137, v137
    v_exp_f32 v138, v138
    v_exp_f32 v139, v139
    v_cvt_pk_bf16_f32 v148, v136, v137
    v_cvt_pk_bf16_f32 v149, v138, v139
    v_mfma_f32_32x32x16_bf16 v[96:111], v[160:163], v[144:147], v[96:111]
    v_exp_f32 v140, v140
    v_exp_f32 v141, v141
    v_exp_f32 v142, v142
    v_exp_f32 v143, v143
    v_cvt_pk_bf16_f32 v150, v140, v141
    v_cvt_pk_bf16_f32 v151, v142, v143
    v_mfma_f32_32x32x16_bf16 v[128:143], v[168:171], v[24:27], 0
    s_setprio 2
    v_exp_f32 v112, v112
    v_exp_f32 v113, v113
    v_exp_f32 v114, v114
    v_exp_f32 v115, v115
    v_cvt_pk_bf16_f32 v144, v112, v113
    v_cvt_pk_bf16_f32 v145, v114, v115
    v_mfma_f32_32x32x16_bf16 v[128:143], v[172:175], v[28:31], v[128:143]
    buffer_load_dwordx4 v[160:163], v4, s[56:59], s15 offen offset:2048 sc1
    v_exp_f32 v116, v116
    v_exp_f32 v117, v117
    v_exp_f32 v118, v118
    v_exp_f32 v119, v119
    v_cvt_pk_bf16_f32 v146, v116, v117
    v_cvt_pk_bf16_f32 v147, v118, v119
    v_mfma_f32_32x32x16_bf16 v[96:111], v[164:167], v[148:151], v[96:111]
    buffer_load_dwordx4 v[164:167], v4, s[56:59], s15 offen offset:3072 sc1
    v_exp_f32 v120, v120
    v_exp_f32 v121, v121
    v_exp_f32 v122, v122
    v_exp_f32 v123, v123
    v_cvt_pk_bf16_f32 v148, v120, v121
    v_cvt_pk_bf16_f32 v149, v122, v123
    v_mfma_f32_32x32x16_bf16 v[48:63], v[176:179], v[144:147], v[48:63]
    s_setprio 0
    v_exp_f32 v124, v124
    v_exp_f32 v125, v125
    v_exp_f32 v126, v126
    v_exp_f32 v127, v127
    v_cvt_pk_bf16_f32 v150, v124, v125
    v_cvt_pk_bf16_f32 v151, v126, v127
    v_mfma_f32_32x32x16_bf16 v[112:127], v[168:171], v[32:35], 0
    s_add_u32 s15, s15, 4096
    v_exp_f32 v128, v128
    v_exp_f32 v129, v129
    v_exp_f32 v130, v130
    v_exp_f32 v131, v131
    v_cvt_pk_bf16_f32 v144, v128, v129
    v_cvt_pk_bf16_f32 v145, v130, v131
    v_mfma_f32_32x32x16_bf16 v[112:127], v[172:175], v[36:39], v[112:127]
    s_and_b32 s15, s15, 0xffff
    v_exp_f32 v132, v132
    v_exp_f32 v133, v133
    v_exp_f32 v134, v134
    v_exp_f32 v135, v135
    v_cvt_pk_bf16_f32 v146, v132, v133
    v_cvt_pk_bf16_f32 v147, v134, v135
    v_mfma_f32_32x32x16_bf16 v[48:63], v[180:183], v[148:151], v[48:63]
    v_exp_f32 v136, v136
    v_exp_f32 v137, v137
    v_exp_f32 v138, v138
    v_exp_f32 v139, v139
    v_cvt_pk_bf16_f32 v148, v136, v137
    v_cvt_pk_bf16_f32 v149, v138, v139
    v_mfma_f32_32x32x16_bf16 v[64:79], v[176:179], v[144:147], v[64:79]
    s_setprio 2
    v_exp_f32 v140, v140
    v_exp_f32 v141, v141
    v_exp_f32 v142, v142
    v_exp_f32 v143, v143
    v_cvt_pk_bf16_f32 v150, v140, v141
    v_cvt_pk_bf16_f32 v151, v142, v143
    v_mfma_f32_32x32x16_bf16 v[128:143], v[168:171], v[40:43], 0
    buffer_load_dwordx4 v[168:171], v4, s[56:59], s15 offen offset:0 sc1
    v_exp_f32 v112, v112
    v_exp_f32 v113, v113
    v_exp_f32 v114, v114
    v_exp_f32 v115, v115
    v_cvt_pk_bf16_f32 v144, v112, v113
    v_cvt_pk_bf16_f32 v145, v114, v115
    v_mfma_f32_32x32x16_bf16 v[128:143], v[172:175], v[44:47], v[128:143]
    buffer_load_dwordx4 v[172:175], v4, s[56:59], s15 offen offset:1024 sc1
    v_exp_f32 v116, v116
    v_exp_f32 v117, v117
    v_exp_f32 v118, v118
    v_exp_f32 v119, v119
    v_cvt_pk_bf16_f32 v146, v116, v117
    v_cvt_pk_bf16_f32 v147, v118, v119
    v_mfma_f32_32x32x16_bf16 v[64:79], v[180:183], v[148:151], v[64:79]
    s_setprio 0
    v_exp_f32 v120, v120
    v_exp_f32 v121, v121
    v_exp_f32 v122, v122
    v_exp_f32 v123, v123
    v_cvt_pk_bf16_f32 v148, v120, v121
    v_cvt_pk_bf16_f32 v149, v122, v123
    v_mfma_f32_32x32x16_bf16 v[80:95], v[176:179], v[144:147], v[80:95]
    s_waitcnt vmcnt(10)
    v_exp_f32 v124, v124
    v_exp_f32 v125, v125
    v_exp_f32 v126, v126
    v_exp_f32 v127, v127
    v_cvt_pk_bf16_f32 v150, v124, v125
    v_cvt_pk_bf16_f32 v151, v126, v127
    v_mfma_f32_32x32x16_bf16 v[112:127], v[184:187], v[16:19], 0
    v_exp_f32 v128, v128
    v_exp_f32 v129, v129
    v_exp_f32 v130, v130
    v_exp_f32 v131, v131
    v_cvt_pk_bf16_f32 v144, v128, v129
    v_cvt_pk_bf16_f32 v145, v130, v131
    v_mfma_f32_32x32x16_bf16 v[112:127], v[188:191], v[20:23], v[112:127]
    v_exp_f32 v132, v132
    v_exp_f32 v133, v133
    v_exp_f32 v134, v134
    v_exp_f32 v135, v135
    v_cvt_pk_bf16_f32 v146, v132, v133
    v_cvt_pk_bf16_f32 v147, v134, v135
    v_mfma_f32_32x32x16_bf16 v[80:95], v[180:183], v[148:151], v[80:95]
    v_exp_f32 v136, v136
    v_exp_f32 v137, v137
    v_exp_f32 v138, v138
    v_exp_f32 v139, v139
    v_cvt_pk_bf16_f32 v148, v136, v137
    v_cvt_pk_bf16_f32 v149, v138, v139
    v_mfma_f32_32x32x16_bf16 v[96:111], v[176:179], v[144:147], v[96:111]
    v_exp_f32 v140, v140
    v_exp_f32 v141, v141
    v_exp_f32 v142, v142
    v_exp_f32 v143, v143
    v_cvt_pk_bf16_f32 v150, v140, v141
    v_cvt_pk_bf16_f32 v151, v142, v143
    v_mfma_f32_32x32x16_bf16 v[128:143], v[184:187], v[24:27], 0
    s_setprio 2
    v_exp_f32 v112, v112
    v_exp_f32 v113, v113
    v_exp_f32 v114, v114
    v_exp_f32 v115, v115
    v_cvt_pk_bf16_f32 v144, v112, v113
    v_cvt_pk_bf16_f32 v145, v114, v115
    v_mfma_f32_32x32x16_bf16 v[128:143], v[188:191], v[28:31], v[128:143]
    buffer_load_dwordx4 v[176:179], v4, s[56:59], s15 offen offset:2048 sc1
    v_exp_f32 v116, v116
    v_exp_f32 v117, v117
    v_exp_f32 v118, v118
    v_exp_f32 v119, v119
    v_cvt_pk_bf16_f32 v146, v116, v117
    v_cvt_pk_bf16_f32 v147, v118, v119
    v_mfma_f32_32x32x16_bf16 v[96:111], v[180:183], v[148:151], v[96:111]
    buffer_load_dwordx4 v[180:183], v4, s[56:59], s15 offen offset:3072 sc1
    v_exp_f32 v120, v120
    v_exp_f32 v121, v121
    v_exp_f32 v122, v122
    v_exp_f32 v123, v123
    v_cvt_pk_bf16_f32 v148, v120, v121
    v_cvt_pk_bf16_f32 v149, v122, v123
    v_mfma_f32_32x32x16_bf16 v[48:63], v[192:195], v[144:147], v[48:63]
    s_setprio 0
    v_exp_f32 v124, v124
    v_exp_f32 v125, v125
    v_exp_f32 v126, v126
    v_exp_f32 v127, v127
    v_cvt_pk_bf16_f32 v150, v124, v125
    v_cvt_pk_bf16_f32 v151, v126, v127
    v_mfma_f32_32x32x16_bf16 v[112:127], v[184:187], v[32:35], 0
    s_add_u32 s15, s15, 4096
    v_exp_f32 v128, v128
    v_exp_f32 v129, v129
    v_exp_f32 v130, v130
    v_exp_f32 v131, v131
    v_cvt_pk_bf16_f32 v144, v128, v129
    v_cvt_pk_bf16_f32 v145, v130, v131
    v_mfma_f32_32x32x16_bf16 v[112:127], v[188:191], v[36:39], v[112:127]
    s_and_b32 s15, s15, 0xffff
    v_exp_f32 v132, v132
    v_exp_f32 v133, v133
    v_exp_f32 v134, v134
    v_exp_f32 v135, v135
    v_cvt_pk_bf16_f32 v146, v132, v133
    v_cvt_pk_bf16_f32 v147, v134, v135
    v_mfma_f32_32x32x16_bf16 v[48:63], v[196:199], v[148:151], v[48:63]
    v_exp_f32 v136, v136
    v_exp_f32 v137, v137
    v_exp_f32 v138, v138
    v_exp_f32 v139, v139
    v_cvt_pk_bf16_f32 v148, v136, v137
    v_cvt_pk_bf16_f32 v149, v138, v139
    v_mfma_f32_32x32x16_bf16 v[64:79], v[192:195], v[144:147], v[64:79]
    s_setprio 2
    v_exp_f32 v140, v140
    v_exp_f32 v141, v141
    v_exp_f32 v142, v142
    v_exp_f32 v143, v143
    v_cvt_pk_bf16_f32 v150, v140, v141
    v_cvt_pk_bf16_f32 v151, v142, v143
    v_mfma_f32_32x32x16_bf16 v[128:143], v[184:187], v[40:43], 0
    buffer_load_dwordx4 v[184:187], v4, s[56:59], s15 offen offset:0 sc1
    v_exp_f32 v112, v112
    v_exp_f32 v113, v113
    v_exp_f32 v114, v114
    v_exp_f32 v115, v115
    v_cvt_pk_bf16_f32 v144, v112, v113
    v_cvt_pk_bf16_f32 v145, v114, v115
    v_mfma_f32_32x32x16_bf16 v[128:143], v[188:191], v[44:47], v[128:143]
    buffer_load_dwordx4 v[188:191], v4, s[56:59], s15 offen offset:1024 sc1
    v_exp_f32 v116, v116
    v_exp_f32 v117, v117
    v_exp_f32 v118, v118
    v_exp_f32 v119, v119
    v_cvt_pk_bf16_f32 v146, v116, v117
    v_cvt_pk_bf16_f32 v147, v118, v119
    v_mfma_f32_32x32x16_bf16 v[64:79], v[196:199], v[148:151], v[64:79]
    s_setprio 0
    v_exp_f32 v120, v120
    v_exp_f32 v121, v121
    v_exp_f32 v122, v122
    v_exp_f32 v123, v123
    v_cvt_pk_bf16_f32 v148, v120, v121
    v_cvt_pk_bf16_f32 v149, v122, v123
    v_mfma_f32_32x32x16_bf16 v[80:95], v[192:195], v[144:147], v[80:95]
    s_waitcnt vmcnt(10)
    v_exp_f32 v124, v124
    v_exp_f32 v125, v125
    v_exp_f32 v126, v126
    v_exp_f32 v127, v127
    v_cvt_pk_bf16_f32 v150, v124, v125
    v_cvt_pk_bf16_f32 v151, v126, v127
    v_mfma_f32_32x32x16_bf16 v[112:127], v[200:203], v[16:19], 0
    v_exp_f32 v128, v128
    v_exp_f32 v129, v129
    v_exp_f32 v130, v130
    v_exp_f32 v131, v131
    v_cvt_pk_bf16_f32 v144, v128, v129
    v_cvt_pk_bf16_f32 v145, v130, v131
    v_mfma_f32_32x32x16_bf16 v[112:127], v[204:207], v[20:23], v[112:127]
    v_exp_f32 v132, v132
    v_exp_f32 v133, v133
    v_exp_f32 v134, v134
    v_exp_f32 v135, v135
    v_cvt_pk_bf16_f32 v146, v132, v133
    v_cvt_pk_bf16_f32 v147, v134, v135
    v_mfma_f32_32x32x16_bf16 v[80:95], v[196:199], v[148:151], v[80:95]
    v_exp_f32 v136, v136
    v_exp_f32 v137, v137
    v_exp_f32 v138, v138
    v_exp_f32 v139, v139
    v_cvt_pk_bf16_f32 v148, v136, v137
    v_cvt_pk_bf16_f32 v149, v138, v139
    v_mfma_f32_32x32x16_bf16 v[96:111], v[192:195], v[144:147], v[96:111]
    v_exp_f32 v140, v140
    v_exp_f32 v141, v141
    v_exp_f32 v142, v142
    v_exp_f32 v143, v143
    v_cvt_pk_bf16_f32 v150, v140, v141
    v_cvt_pk_bf16_f32 v151, v142, v143
    v_mfma_f32_32x32x16_bf16 v[128:143], v[200:203], v[24:27], 0
    s_setprio 2
    v_exp_f32 v112, v112
    v_exp_f32 v113, v113
    v_exp_f32 v114, v114
    v_exp_f32 v115, v115
    v_cvt_pk_bf16_f32 v144, v112, v113
    v_cvt_pk_bf16_f32 v145, v114, v115
    v_mfma_f32_32x32x16_bf16 v[128:143], v[204:207], v[28:31], v[128:143]
    buffer_load_dwordx4 v[192:195], v4, s[56:59], s15 offen offset:2048 sc1
    v_exp_f32 v116, v116
    v_exp_f32 v117, v117
    v_exp_f32 v118, v118
    v_exp_f32 v119, v119
    v_cvt_pk_bf16_f32 v146, v116, v117
    v_cvt_pk_bf16_f32 v147, v118, v119
    v_mfma_f32_32x32x16_bf16 v[96:111], v[196:199], v[148:151], v[96:111]
    buffer_load_dwordx4 v[196:199], v4, s[56:59], s15 offen offset:3072 sc1
    v_exp_f32 v120, v120
    v_exp_f32 v121, v121
    v_exp_f32 v122, v122
    v_exp_f32 v123, v123
    v_cvt_pk_bf16_f32 v148, v120, v121
    v_cvt_pk_bf16_f32 v149, v122, v123
    v_mfma_f32_32x32x16_bf16 v[48:63], v[208:211], v[144:147], v[48:63]
    s_setprio 0
    v_exp_f32 v124, v124
    v_exp_f32 v125, v125
    v_exp_f32 v126, v126
    v_exp_f32 v127, v127
    v_cvt_pk_bf16_f32 v150, v124, v125
    v_cvt_pk_bf16_f32 v151, v126, v127
    v_mfma_f32_32x32x16_bf16 v[112:127], v[200:203], v[32:35], 0
    s_add_u32 s15, s15, 4096
    v_exp_f32 v128, v128
    v_exp_f32 v129, v129
    v_exp_f32 v130, v130
    v_exp_f32 v131, v131
    v_cvt_pk_bf16_f32 v144, v128, v129
    v_cvt_pk_bf16_f32 v145, v130, v131
    v_mfma_f32_32x32x16_bf16 v[112:127], v[204:207], v[36:39], v[112:127]
    s_and_b32 s15, s15, 0xffff
    v_exp_f32 v132, v132
    v_exp_f32 v133, v133
    v_exp_f32 v134, v134
    v_exp_f32 v135, v135
    v_cvt_pk_bf16_f32 v146, v132, v133
    v_cvt_pk_bf16_f32 v147, v134, v135
    v_mfma_f32_32x32x16_bf16 v[48:63], v[212:215], v[148:151], v[48:63]
    ds_read_b32 v12, v14 offset:20
    v_exp_f32 v136, v136
    v_exp_f32 v137, v137
    v_exp_f32 v138, v138
    v_exp_f32 v139, v139
    v_cvt_pk_bf16_f32 v148, v136, v137
    v_cvt_pk_bf16_f32 v149, v138, v139
    v_mfma_f32_32x32x16_bf16 v[64:79], v[208:211], v[144:147], v[64:79]
    s_setprio 2
    v_exp_f32 v140, v140
    v_exp_f32 v141, v141
    v_exp_f32 v142, v142
    v_exp_f32 v143, v143
    v_cvt_pk_bf16_f32 v150, v140, v141
    v_cvt_pk_bf16_f32 v151, v142, v143
    v_mfma_f32_32x32x16_bf16 v[128:143], v[200:203], v[40:43], 0
    buffer_load_dwordx4 v[200:203], v4, s[56:59], s15 offen offset:0 sc1
    v_exp_f32 v112, v112
    v_exp_f32 v113, v113
    v_exp_f32 v114, v114
    v_exp_f32 v115, v115
    v_cvt_pk_bf16_f32 v144, v112, v113
    v_cvt_pk_bf16_f32 v145, v114, v115
    v_mfma_f32_32x32x16_bf16 v[128:143], v[204:207], v[44:47], v[128:143]
    buffer_load_dwordx4 v[204:207], v4, s[56:59], s15 offen offset:1024 sc1
    v_exp_f32 v116, v116
    v_exp_f32 v117, v117
    v_exp_f32 v118, v118
    v_exp_f32 v119, v119
    v_cvt_pk_bf16_f32 v146, v116, v117
    v_cvt_pk_bf16_f32 v147, v118, v119
    v_mfma_f32_32x32x16_bf16 v[64:79], v[212:215], v[148:151], v[64:79]
    s_setprio 0
    v_exp_f32 v120, v120
    v_exp_f32 v121, v121
    v_exp_f32 v122, v122
    v_exp_f32 v123, v123
    v_cvt_pk_bf16_f32 v148, v120, v121
    v_cvt_pk_bf16_f32 v149, v122, v123
    v_mfma_f32_32x32x16_bf16 v[80:95], v[208:211], v[144:147], v[80:95]
    s_waitcnt vmcnt(10)
    v_exp_f32 v124, v124
    v_exp_f32 v125, v125
    v_exp_f32 v126, v126
    v_exp_f32 v127, v127
    v_cvt_pk_bf16_f32 v150, v124, v125
    v_cvt_pk_bf16_f32 v151, v126, v127
    v_mfma_f32_32x32x16_bf16 v[112:127], v[152:155], v[16:19], 0
    v_exp_f32 v128, v128
    v_exp_f32 v129, v129
    v_exp_f32 v130, v130
    v_exp_f32 v131, v131
    v_cvt_pk_bf16_f32 v144, v128, v129
    v_cvt_pk_bf16_f32 v145, v130, v131
    v_mfma_f32_32x32x16_bf16 v[112:127], v[156:159], v[20:23], v[112:127]
    v_exp_f32 v132, v132
    v_exp_f32 v133, v133
    v_exp_f32 v134, v134
    v_exp_f32 v135, v135
    v_cvt_pk_bf16_f32 v146, v132, v133
    v_cvt_pk_bf16_f32 v147, v134, v135
    v_mfma_f32_32x32x16_bf16 v[80:95], v[212:215], v[148:151], v[80:95]
    s_sub_u32 s14, s14, 1
    v_exp_f32 v136, v136
    v_exp_f32 v137, v137
    v_exp_f32 v138, v138
    v_exp_f32 v139, v139
    v_cvt_pk_bf16_f32 v148, v136, v137
    v_cvt_pk_bf16_f32 v149, v138, v139
    v_mfma_f32_32x32x16_bf16 v[96:111], v[208:211], v[144:147], v[96:111]
    s_cmp_lg_u32 s14, 0
    v_exp_f32 v140, v140
    v_exp_f32 v141, v141
    v_exp_f32 v142, v142
    v_exp_f32 v143, v143
    v_cvt_pk_bf16_f32 v150, v140, v141
    v_cvt_pk_bf16_f32 v151, v142, v143
    s_cbranch_scc1 F_LOOP
    s_nop 0
    v_mfma_f32_32x32x16_bf16 v[96:111], v[212:215], v[148:151], v[96:111]
    s_setprio 3
    s_waitcnt lgkmcnt(0)
    v_readfirstlane_b32 s78, v12
    s_nop 0
    s_cmp_ge_u32 s78, 8
    s_cbranch_scc1 F_WOK
    s_mov_b32 s79, 262144
LW_17:
    ds_read_b32 v5, v14 offset:20
    s_waitcnt lgkmcnt(0)
    v_readfirstlane_b32 s78, v5
    s_nop 0
    s_cmp_ge_u32 s78, 8
    s_cbranch_scc1 LD_18
    s_sleep 1
    s_sub_u32 s79, s79, 1
    s_cmp_lg_u32 s79, 0
    s_cbranch_scc1 LW_17
LD_18:
F_WOK:
    s_mul_i32 s14, s68, 12288
    s_add_u32 s14, s14, 0
    v_add_u32 v13, s14, v4
    ds_write_b128 v13, v[48:51] offset:0
    ds_write_b128 v13, v[52:55] offset:1024
    ds_write_b128 v13, v[56:59] offset:2048
    ds_write_b128 v13, v[60:63] offset:3072
    s_mul_i32 s14, s69, 12288
    s_add_u32 s14, s14, 0
    v_add_u32 v13, s14, v4
    ds_write_b128 v13, v[64:67] offset:4096
    ds_write_b128 v13, v[68:71] offset:5120
    ds_write_b128 v13, v[72:75] offset:6144
    ds_write_b128 v13, v[76:79] offset:7168
    s_mul_i32 s14, s70, 12288
    s_add_u32 s14, s14, 0
    v_add_u32 v13, s14, v4
    ds_write_b128 v13, v[80:83] offset:8192
    ds_write_b128 v13, v[84:87] offset:9216
    ds_write_b128 v13, v[88:91] offset:10240
    ds_write_b128 v13, v[92:95] offset:11264
    s_mul_i32 s14, s3, 12288
    s_add_u32 s14, s14, 0
    v_add_u32 v13, s14, v4
    s_lshl_b32 s14, s50, 1
    s_lshr_b32 s12, s3, 1
    s_add_u32 s14, s14, s12
    s_lshl_b32 s14, s14, 4
    s_lshl_b32 s12, s51, 1
    s_add_u32 s14, s14, s12
    s_and_b32 s12, s3, 1
    s_add_u32 s14, s14, s12
    s_lshl_b32 s12, s14, 6
    s_add_u32 s12, s12, 16384
    s_lshl_b32 s14, s14, 11
    v_min3_f32 v8, v60, v76, v92
    v_max3_f32 v9, v60, v76, v92
    v_min_f32 v8, v8, v108
    v_max_f32 v9, v9, v108
    v_cmp_nle_f32 vcc, 0x1f800000, v8
    s_nop 0
    s_and_b64 s[8:9], vcc, s[74:75]
    v_cmp_nge_f32 vcc, 0x5f800000, v9
    s_nop 0
    s_and_b64 vcc, vcc, s[74:75]
    s_or_b64 s[8:9], s[8:9], vcc
    s_cselect_b32 s8, 0x10001, 1
    v_mov_b32 v8, s8
    s_waitcnt lgkmcnt(0)
    s_mov_b64 exec, 1
    ds_add_u32 v14, v8 offset:16
    s_mov_b64 exec, -1
    s_mov_b32 s79, 262144
F_RW:
    ds_read_b32 v5, v14 offset:16
    s_waitcnt lgkmcnt(0)
    v_readfirstlane_b32 s78, v5
    s_nop 0
    s_and_b32 s8, s78, 0xffff
    s_cmp_ge_u32 s8, s4
    s_cbranch_scc1 F_RD
    s_sub_u32 s79, s79, 1
    s_cmp_lg_u32 s79, 0
    s_cbranch_scc1 F_RW
F_RD:
    s_cmp_eq_u32 s78, 4
    s_cbranch_scc0 F_FBQ
F_RGO:
    ds_read_b128 v[60:63], v13 offset:3072
    ds_read_b128 v[76:79], v13 offset:7168
    ds_read_b128 v[92:95], v13 offset:11264
    ds_read_b128 v[48:51], v13 offset:0
    ds_read_b128 v[64:67], v13 offset:4096
    ds_read_b128 v[80:83], v13 offset:8192
    ds_read_b128 v[52:55], v13 offset:1024
    ds_read_b128 v[68:71], v13 offset:5120
    ds_read_b128 v[84:87], v13 offset:9216
    ds_read_b128 v[56:59], v13 offset:2048
    ds_read_b128 v[72:75], v13 offset:6144
    ds_read_b128 v[88:91], v13 offset:10240
    s_waitcnt lgkmcnt(9)
    v_pk_add_f32 v[108:109], v[108:109], v[60:61]
    v_pk_add_f32 v[110:111], v[110:111], v[62:63]
    v_pk_add_f32 v[108:109], v[108:109], v[76:77]
    v_pk_add_f32 v[110:111], v[110:111], v[78:79]
    v_pk_add_f32 v[108:109], v[108:109], v[92:93]
    v_pk_add_f32 v[110:111], v[110:111], v[94:95]
    v_mov_b32 v12, v108
    v_mov_b32 v10, v108
    s_nop 1
    v_permlane32_swap_b32 v12, v10
    v_rcp_f32 v10, v10
    s_waitcnt lgkmcnt(6)
    v_pk_add_f32 v[96:97], v[96:97], v[48:49]
    v_pk_add_f32 v[98:99], v[98:99], v[50:51]
    v_pk_add_f32 v[96:97], v[96:97], v[64:65]
    v_pk_add_f32 v[98:99], v[98:99], v[66:67]
    v_pk_add_f32 v[96:97], v[96:97], v[80:81]
    v_pk_add_f32 v[98:99], v[98:99], v[82:83]
    s_waitcnt lgkmcnt(3)
    v_pk_add_f32 v[100:101], v[100:101], v[52:53]
    v_pk_add_f32 v[102:103], v[102:103], v[54:55]
    v_pk_add_f32 v[100:101], v[100:101], v[68:69]
    v_pk_add_f32 v[102:103], v[102:103], v[70:71]
    v_pk_add_f32 v[100:101], v[100:101], v[84:85]
    v_pk_add_f32 v[102:103], v[102:103], v[86:87]
    s_waitcnt lgkmcnt(0)
    v_pk_add_f32 v[104:105], v[104:105], v[56:57]
    v_pk_add_f32 v[106:107], v[106:107], v[58:59]
    v_pk_add_f32 v[104:105], v[104:105], v[72:73]
    v_pk_add_f32 v[106:107], v[106:107], v[74:75]
    v_pk_add_f32 v[104:105], v[104:105], v[88:89]
    v_pk_add_f32 v[106:107], v[106:107], v[90:91]
    v_pk_mul_f32 v[96:97], v[96:97], v[10:11] op_sel_hi:[1,0]
    v_pk_mul_f32 v[98:99], v[98:99], v[10:11] op_sel_hi:[1,0]
    v_pk_mul_f32 v[100:101], v[100:101], v[10:11] op_sel_hi:[1,0]
    v_pk_mul_f32 v[102:103], v[102:103], v[10:11] op_sel_hi:[1,0]
    v_pk_mul_f32 v[104:105], v[104:105], v[10:11] op_sel_hi:[1,0]
    v_pk_mul_f32 v[106:107], v[106:107], v[10:11] op_sel_hi:[1,0]
    v_pk_mul_f32 v[108:109], v[108:109], v[10:11] op_sel_hi:[1,0]
    v_pk_mul_f32 v[110:111], v[110:111], v[10:11] op_sel_hi:[1,0]
    v_cvt_pk_bf16_f32 v144, v96, v97
    v_cvt_pk_bf16_f32 v145, v98, v99
    v_cvt_pk_bf16_f32 v146, v100, v101
    v_cvt_pk_bf16_f32 v147, v102, v103
    v_cvt_pk_bf16_f32 v148, v104, v105
    v_cvt_pk_bf16_f32 v149, v106, v107
    v_cvt_pk_bf16_f32 v150, v108, v109
    v_cvt_pk_bf16_f32 v151, v110, v111
    v_cndmask_b32 v150, v150, 0, s[74:75]
    v_cndmask_b32 v151, v151, 0, s[74:75]
    buffer_store_dwordx4 v[144:147], v4, s[60:63], s14 offen sc1
    buffer_store_dwordx4 v[148:151], v4, s[60:63], s14 offen offset:1024 sc1
    s_mov_b64 exec, 1
    ds_add_u32 v14, v15 offset:24
    s_mov_b64 exec, -1
    v_mov_b32 v8, s77
    v_mov_b32 v9, 0
    s_and_b32 s9, s3, 1
    s_lshr_b32 s10, s3, 1
    v_lshrrev_b32 v5, 1, v3
    v_lshrrev_b32 v7, 2, v2
    v_lshl_add_u32 v5, v5, 2, v7
    v_lshlrev_b32 v5, 7, v5
    v_lshrrev_b32 v7, 3, v2
    v_lshl_add_u32 v5, v7, 6, v5
    v_and_b32 v7, 1, v3
    v_lshl_add_u32 v5, v7, 5, v5
    v_and_b32 v7, 3, v2
    v_lshl_add_u32 v5, v7, 3, v5
    s_lshl_b32 s13, s10, 6
    v_xor_b32 v5, s13, v5
    s_mul_i32 s13, s10, 28672
    s_add_u32 s13, s13, 98304
    v_add_u32 v18, s13, v5
    v_xor_b32 v19, 64, v18
    ds_read_b64_tr_b16 v[88:89], v18 offset:0
    ds_read_b64_tr_b16 v[90:91], v18 offset:1024
    ds_read_b64_tr_b16 v[92:93], v19 offset:0
    ds_read_b64_tr_b16 v[94:95], v19 offset:1024
    ds_read_b64_tr_b16 v[96:97], v18 offset:2048
    ds_read_b64_tr_b16 v[98:99], v18 offset:3072
    ds_read_b64_tr_b16 v[100:101], v19 offset:2048
    ds_read_b64_tr_b16 v[102:103], v19 offset:3072
    ds_read_b64_tr_b16 v[104:105], v18 offset:3584
    ds_read_b64_tr_b16 v[106:107], v18 offset:4608
    ds_read_b64_tr_b16 v[108:109], v19 offset:3584
    ds_read_b64_tr_b16 v[110:111], v19 offset:4608
    ds_read_b64_tr_b16 v[112:113], v18 offset:5632
    ds_read_b64_tr_b16 v[114:115], v18 offset:6656
    ds_read_b64_tr_b16 v[116:117], v19 offset:5632
    ds_read_b64_tr_b16 v[118:119], v19 offset:6656
    ds_read_b64_tr_b16 v[120:121], v18 offset:7168
    ds_read_b64_tr_b16 v[122:123], v18 offset:8192
    ds_read_b64_tr_b16 v[124:125], v19 offset:7168
    ds_read_b64_tr_b16 v[126:127], v19 offset:8192
    ds_read_b64_tr_b16 v[128:129], v18 offset:9216
    ds_read_b64_tr_b16 v[130:131], v18 offset:10240
    ds_read_b64_tr_b16 v[132:133], v19 offset:9216
    ds_read_b64_tr_b16 v[134:135], v19 offset:10240
    s_waitcnt vmcnt(0)
    s_mov_b64 exec, 1
    buffer_store_dword v8, v9, s[64:67], s12 offen sc1
    s_mov_b64 exec, -1
    s_cmp_eq_u32 s51, 7
    s_cbranch_scc1 F_BEND
    ds_read_b64_tr_b16 v[136:137], v18 offset:10752
    ds_read_b64_tr_b16 v[138:139], v18 offset:11776
    ds_read_b64_tr_b16 v[140:141], v19 offset:10752
    ds_read_b64_tr_b16 v[142:143], v19 offset:11776
    ds_read_b64_tr_b16 v[152:153], v18 offset:14336
    ds_read_b64_tr_b16 v[154:155], v18 offset:15360
    ds_read_b64_tr_b16 v[156:157], v19 offset:14336
    ds_read_b64_tr_b16 v[158:159], v19 offset:15360
    ds_read_b64_tr_b16 v[160:161], v18 offset:16384
    ds_read_b64_tr_b16 v[162:163], v18 offset:17408
    ds_read_b64_tr_b16 v[164:165], v19 offset:16384
    ds_read_b64_tr_b16 v[166:167], v19 offset:17408
    ds_read_b64_tr_b16 v[168:169], v18 offset:17920
    ds_read_b64_tr_b16 v[170:171], v18 offset:18944
    ds_read_b64_tr_b16 v[172:173], v19 offset:17920
    ds_read_b64_tr_b16 v[174:175], v19 offset:18944
    ds_read_b64_tr_b16 v[176:177], v18 offset:19968
    ds_read_b64_tr_b16 v[178:179], v18 offset:20992
    ds_read_b64_tr_b16 v[180:181], v19 offset:19968
    ds_read_b64_tr_b16 v[182:183], v19 offset:20992
    ds_read_b64_tr_b16 v[184:185], v18 offset:21504
    ds_read_b64_tr_b16 v[186:187], v18 offset:22528
    ds_read_b64_tr_b16 v[188:189], v19 offset:21504
    ds_read_b64_tr_b16 v[190:191], v19 offset:22528
    ds_read_b64_tr_b16 v[192:193], v18 offset:23552
    ds_read_b64_tr_b16 v[194:195], v18 offset:24576
    ds_read_b64_tr_b16 v[196:197], v19 offset:23552
    ds_read_b64_tr_b16 v[198:199], v19 offset:24576
    ds_read_b64_tr_b16 v[200:201], v18 offset:25088
    ds_read_b64_tr_b16 v[202:203], v18 offset:26112
    ds_read_b64_tr_b16 v[204:205], v19 offset:25088
    ds_read_b64_tr_b16 v[206:207], v19 offset:26112
    ds_read_b64_tr_b16 v[208:209], v18 offset:27136
    ds_read_b64_tr_b16 v[210:211], v18 offset:28160
    ds_read_b64_tr_b16 v[212:213], v19 offset:27136
    ds_read_b64_tr_b16 v[214:215], v19 offset:28160
    ds_read_b64_tr_b16 v[144:145], v18 offset:12800
    ds_read_b64_tr_b16 v[146:147], v18 offset:13824
    ds_read_b64_tr_b16 v[148:149], v19 offset:12800
    ds_read_b64_tr_b16 v[150:151], v19 offset:13824
    v_and_b32 v5, 7, v1
    v_lshlrev_b32 v21, 6, v5
    s_lshl_b32 s14, s50, 1
    s_add_u32 s14, s14, s9
    s_mul_i32 s8, s14, 114688
    s_lshl_b32 s14, s14, 4
    s_lshl_b32 s12, s10, 3
    s_add_u32 s14, s14, s12
    s_lshl_b32 s12, s14, 6
    s_add_u32 s12, s12, 16384
    s_lshl_b32 s14, s14, 11
    s_mov_b32 s52, s44
    s_mov_b32 s53, s45
    s_mov_b32 s54, 7340032
    s_mov_b32 s55, 0x00020000
    v_lshrrev_b32 v5, 5, v1
    v_mul_u32_u24 v20, 14336, v5
    v_and_b32 v5, 31, v1
    v_lshl_add_u32 v20, v5, 2, v20
    s_lshl_b32 s13, s51, 8
    s_add_u32 s8, s8, s13
    s_lshl_b32 s13, s10, 7
    s_add_u32 s8, s8, s13
    s_add_u32 s13, s8, 1792
    s_lshl_b32 s8, s3, 12
    s_add_u32 s8, s8, 0
    v_add_u32 v16, s8, v4
    s_xor_b32 s8, s3, 2
    s_lshl_b32 s8, s8, 12
    s_add_u32 s8, s8, 0
    v_add_u32 v17, s8, v4
    s_lshl_b32 s8, s9, 2
    v_add_u32 v22, s8, v14
    s_mul_i32 s8, s51, 19
    v_min_u32 v23, 18, v1
    v_add_u32 v23, s8, v23
    v_min_u32 v23, 127, v23
    v_lshlrev_b32 v23, 7, v23
    s_mov_b32 s79, 262144
LW_19:
    ds_read_b32 v5, v14 offset:24
    s_waitcnt lgkmcnt(0)
    v_readfirstlane_b32 s78, v5
    s_nop 0
    s_cmp_ge_u32 s78, 4
    s_cbranch_scc1 LD_20
    s_sleep 1
    s_sub_u32 s79, s79, 1
    s_cmp_lg_u32 s79, 0
    s_cbranch_scc1 LW_19
LD_20:
    s_waitcnt lgkmcnt(0)
    s_mov_b32 s79, 262144
PW_21:
    buffer_load_dword v5, v21, s[64:67], s12 offen sc1
    s_waitcnt vmcnt(0)
    v_cmp_ne_u32 vcc, s77, v5
    s_nop 0
    s_cbranch_vccz PD_22
    s_sleep 1
    s_sub_u32 s79, s79, 1
    s_cmp_lg_u32 s79, 0
    s_cbranch_scc1 PW_21
PD_22:
    buffer_load_dwordx4 v[24:27], v4, s[60:63], s14 offen offset:0 sc1
    buffer_load_dwordx4 v[28:31], v4, s[60:63], s14 offen offset:1024 sc1
    buffer_load_dwordx4 v[32:35], v4, s[60:63], s14 offen offset:2048 sc1
    buffer_load_dwordx4 v[36:39], v4, s[60:63], s14 offen offset:3072 sc1
    s_add_u32 s14, s14, 4096
    buffer_load_dwordx4 v[40:43], v4, s[60:63], s14 offen offset:0 sc1
    buffer_load_dwordx4 v[44:47], v4, s[60:63], s14 offen offset:1024 sc1
    buffer_load_dwordx4 v[48:51], v4, s[60:63], s14 offen offset:2048 sc1
    buffer_load_dwordx4 v[52:55], v4, s[60:63], s14 offen offset:3072 sc1
    s_add_u32 s14, s14, 4096
    buffer_load_dwordx4 v[56:59], v4, s[60:63], s14 offen offset:0 sc1
    buffer_load_dwordx4 v[60:63], v4, s[60:63], s14 offen offset:1024 sc1
    buffer_load_dwordx4 v[64:67], v4, s[60:63], s14 offen offset:2048 sc1
    buffer_load_dwordx4 v[68:71], v4, s[60:63], s14 offen offset:3072 sc1
    s_add_u32 s14, s14, 4096
    buffer_load_dwordx4 v[72:75], v4, s[60:63], s14 offen offset:0 sc1
    buffer_load_dwordx4 v[76:79], v4, s[60:63], s14 offen offset:1024 sc1
    buffer_load_dwordx4 v[80:83], v4, s[60:63], s14 offen offset:2048 sc1
    buffer_load_dwordx4 v[84:87], v4, s[60:63], s14 offen offset:3072 sc1
    s_waitcnt vmcnt(14)
    v_mfma_f32_32x32x16_bf16 v[232:247], v[24:27], v[92:95], 0
    v_mfma_f32_32x32x16_bf16 v[216:231], v[24:27], v[88:91], 0
    v_mfma_f32_32x32x16_bf16 v[232:247], v[28:31], v[100:103], v[232:247]
    v_mfma_f32_32x32x16_bf16 v[216:231], v[28:31], v[96:99], v[216:231]
    s_waitcnt vmcnt(12)
    v_mfma_f32_32x32x16_bf16 v[232:247], v[32:35], v[108:111], v[232:247]
    v_mfma_f32_32x32x16_bf16 v[216:231], v[32:35], v[104:107], v[216:231]
    v_mfma_f32_32x32x16_bf16 v[232:247], v[36:39], v[116:119], v[232:247]
    v_mfma_f32_32x32x16_bf16 v[216:231], v[36:39], v[112:115], v[216:231]
    s_waitcnt vmcnt(10)
    v_mfma_f32_32x32x16_bf16 v[232:247], v[40:43], v[124:127], v[232:247]
    v_mfma_f32_32x32x16_bf16 v[216:231], v[40:43], v[120:123], v[216:231]
    v_mfma_f32_32x32x16_bf16 v[232:247], v[44:47], v[132:135], v[232:247]
    v_mfma_f32_32x32x16_bf16 v[216:231], v[44:47], v[128:131], v[216:231]
    s_waitcnt vmcnt(8)
    v_mfma_f32_32x32x16_bf16 v[232:247], v[48:51], v[140:143], v[232:247]
    v_mfma_f32_32x32x16_bf16 v[216:231], v[48:51], v[136:139], v[216:231]
    v_mfma_f32_32x32x16_bf16 v[232:247], v[52:55], v[148:151], v[232:247]
    v_mfma_f32_32x32x16_bf16 v[216:231], v[52:55], v[144:147], v[216:231]
    s_waitcnt vmcnt(6)
    v_mfma_f32_32x32x16_bf16 v[232:247], v[56:59], v[156:159], v[232:247]
    v_mfma_f32_32x32x16_bf16 v[216:231], v[56:59], v[152:155], v[216:231]
    v_mfma_f32_32x32x16_bf16 v[232:247], v[60:63], v[164:167], v[232:247]
    v_mfma_f32_32x32x16_bf16 v[216:231], v[60:63], v[160:163], v[216:231]
    s_waitcnt vmcnt(4)
    v_mfma_f32_32x32x16_bf16 v[232:247], v[64:67], v[172:175], v[232:247]
    v_mfma_f32_32x32x16_bf16 v[216:231], v[64:67], v[168:171], v[216:231]
    v_mfma_f32_32x32x16_bf16 v[232:247], v[68:71], v[180:183], v[232:247]
    v_mfma_f32_32x32x16_bf16 v[216:231], v[68:71], v[176:179], v[216:231]
    s_waitcnt vmcnt(2)
    v_mfma_f32_32x32x16_bf16 v[232:247], v[72:75], v[188:191], v[232:247]
    v_mfma_f32_32x32x16_bf16 v[216:231], v[72:75], v[184:187], v[216:231]
    v_mfma_f32_32x32x16_bf16 v[232:247], v[76:79], v[196:199], v[232:247]
    v_mfma_f32_32x32x16_bf16 v[216:231], v[76:79], v[192:195], v[216:231]
    s_waitcnt vmcnt(0)
    v_mfma_f32_32x32x16_bf16 v[232:247], v[80:83], v[204:207], v[232:247]
    v_mfma_f32_32x32x16_bf16 v[216:231], v[80:83], v[200:203], v[216:231]
    v_mfma_f32_32x32x16_bf16 v[232:247], v[84:87], v[212:215], v[232:247]
    v_mfma_f32_32x32x16_bf16 v[216:231], v[84:87], v[208:211], v[216:231]
    s_nop 10
    ds_write_b128 v16, v[232:235] offset:0
    ds_write_b128 v16, v[236:239] offset:1024
    ds_write_b128 v16, v[240:243] offset:2048
    ds_write_b128 v16, v[244:247] offset:3072
    s_waitcnt lgkmcnt(0)
    v_nop
    v_nop
    s_mov_b64 exec, 1
    ds_add_u32 v22, v15 offset:36
    s_mov_b64 exec, -1
    s_mov_b32 s79, 262144
LW_23:
    ds_read_b32 v5, v22 offset:36
    s_waitcnt lgkmcnt(0)
    v_readfirstlane_b32 s78, v5
    s_nop 0
    s_cmp_ge_u32 s78, 2
    s_cbranch_scc1 LD_24
    s_sleep 0
    s_sub_u32 s79, s79, 1
    s_cmp_lg_u32 s79, 0
    s_cbranch_scc1 LW_23
LD_24:
    ds_read_b128 v[24:27], v17 offset:0
    ds_read_b128 v[28:31], v17 offset:1024
    ds_read_b128 v[32:35], v17 offset:2048
    ds_read_b128 v[36:39], v17 offset:3072
    s_waitcnt lgkmcnt(3)
    v_add_f32 v216, v216, v24
    v_add_f32 v217, v217, v25
    v_add_f32 v218, v218, v26
    v_add_f32 v219, v219, v27
    buffer_store_dword v216, v20, s[52:55], s13 offen sc1
    buffer_store_dword v217, v20, s[52:55], s13 offen offset:3584 sc1
    s_add_u32 s13, s13, 7168
    buffer_store_dword v218, v20, s[52:55], s13 offen sc1
    buffer_store_dword v219, v20, s[52:55], s13 offen offset:3584 sc1
    s_add_u32 s13, s13, 21504
    s_waitcnt lgkmcnt(2)
    v_add_f32 v220, v220, v28
    v_add_f32 v221, v221, v29
    v_add_f32 v222, v222, v30
    v_add_f32 v223, v223, v31
    buffer_store_dword v220, v20, s[52:55], s13 offen sc1
    buffer_store_dword v221, v20, s[52:55], s13 offen offset:3584 sc1
    s_add_u32 s13, s13, 7168
    buffer_store_dword v222, v20, s[52:55], s13 offen sc1
    buffer_store_dword v223, v20, s[52:55], s13 offen offset:3584 sc1
    s_add_u32 s13, s13, 21504
    s_waitcnt lgkmcnt(1)
    v_add_f32 v224, v224, v32
    v_add_f32 v225, v225, v33
    v_add_f32 v226, v226, v34
    v_add_f32 v227, v227, v35
    buffer_store_dword v224, v20, s[52:55], s13 offen sc1
    buffer_store_dword v225, v20, s[52:55], s13 offen offset:3584 sc1
    s_add_u32 s13, s13, 7168
    buffer_store_dword v226, v20, s[52:55], s13 offen sc1
    buffer_store_dword v227, v20, s[52:55], s13 offen offset:3584 sc1
    s_add_u32 s13, s13, 21504
    s_waitcnt lgkmcnt(0)
    v_add_f32 v228, v228, v36
    v_add_f32 v229, v229, v37
    v_add_f32 v230, v230, v38
    v_add_f32 v231, v231, v39
    buffer_store_dword v228, v20, s[52:55], s13 offen sc1
    buffer_store_dword v229, v20, s[52:55], s13 offen offset:3584 sc1
    s_add_u32 s13, s13, 7168
    buffer_store_dword v230, v20, s[52:55], s13 offen sc1
    buffer_store_dword v231, v20, s[52:55], s13 offen offset:3584 sc1
    s_nop 1
F_BEND:
    s_endpgm
F_FBQ:
    s_cmp_lg_u32 s4, 4
    s_cbranch_scc1 F_RGO
    s_waitcnt vmcnt(0)
    s_mov_b32 s58, 65536
    v_mov_b32 v220, 0xff800000
    v_mov_b32 v221, 0xff800000
    v_mov_b32 v222, 0xff800000
    v_mov_b32 v223, 0xff800000
    s_mov_b32 s15, 0
    s_nop 3
F_FBL:
    buffer_load_dwordx4 v[152:155], v4, s[56:59], s15 offen sc1
    buffer_load_dwordx4 v[156:159], v4, s[56:59], s15 offen offset:1024 sc1
    s_waitcnt vmcnt(0)
    v_mfma_f32_32x32x16_bf16 v[112:127], v[152:155], v[16:19], 0
    v_mfma_f32_32x32x16_bf16 v[112:127], v[156:159], v[20:23], v[112:127]
    s_nop 11
    v_max3_f32 v220, v220, v112, v113
    v_max3_f32 v220, v220, v114, v115
    v_max3_f32 v220, v220, v116, v117
    v_max3_f32 v220, v220, v118, v119
    v_max3_f32 v220, v220, v120, v121
    v_max3_f32 v220, v220, v122, v123
    v_max3_f32 v220, v220, v124, v125
    v_max3_f32 v220, v220, v126, v127
    v_mfma_f32_32x32x16_bf16 v[112:127], v[152:155], v[24:27], 0
    v_mfma_f32_32x32x16_bf16 v[112:127], v[156:159], v[28:31], v[112:127]
    s_nop 11
    v_max3_f32 v221, v221, v112, v113
    v_max3_f32 v221, v221, v114, v115
    v_max3_f32 v221, v221, v116, v117
    v_max3_f32 v221, v221, v118, v119
    v_max3_f32 v221, v221, v120, v121
    v_max3_f32 v221, v221, v122, v123
    v_max3_f32 v221, v221, v124, v125
    v_max3_f32 v221, v221, v126, v127
    v_mfma_f32_32x32x16_bf16 v[112:127], v[152:155], v[32:35], 0
    v_mfma_f32_32x32x16_bf16 v[112:127], v[156:159], v[36:39], v[112:127]
    s_nop 11
    v_max3_f32 v222, v222, v112, v113
    v_max3_f32 v222, v222, v114, v115
    v_max3_f32 v222, v222, v116, v117
    v_max3_f32 v222, v222, v118, v119
    v_max3_f32 v222, v222, v120, v121
    v_max3_f32 v222, v222, v122, v123
    v_max3_f32 v222, v222, v124, v125
    v_max3_f32 v222, v222, v126, v127
    v_mfma_f32_32x32x16_bf16 v[112:127], v[152:155], v[40:43], 0
    v_mfma_f32_32x32x16_bf16 v[112:127], v[156:159], v[44:47], v[112:127]
    s_nop 11
    v_max3_f32 v223, v223, v112, v113
    v_max3_f32 v223, v223, v114, v115
    v_max3_f32 v223, v223, v116, v117
    v_max3_f32 v223, v223, v118, v119
    v_max3_f32 v223, v223, v120, v121
    v_max3_f32 v223, v223, v122, v123
    v_max3_f32 v223, v223, v124, v125
    v_max3_f32 v223, v223, v126, v127
    s_add_u32 s15, s15, 4096
    s_cmp_lt_u32 s15, 65536
    s_nop 2
    s_cbranch_scc1 F_FBL
    v_lshlrev_b32 v6, 2, v1
    v_mov_b32 v5, v220
    s_nop 1
    v_permlane32_swap_b32 v220, v5
    v_max_f32 v220, v220, v5
    s_lshl_b32 s8, s68, 10
    s_add_u32 s8, s8, 0
    v_add_u32 v224, s8, v6
    s_lshl_b32 s9, s3, 8
    v_add_u32 v7, s9, v224
    ds_write_b32 v7, v220
    v_mov_b32 v5, v221
    s_nop 1
    v_permlane32_swap_b32 v221, v5
    v_max_f32 v221, v221, v5
    s_lshl_b32 s8, s69, 10
    s_add_u32 s8, s8, 0
    v_add_u32 v225, s8, v6
    s_lshl_b32 s9, s3, 8
    v_add_u32 v7, s9, v225
    ds_write_b32 v7, v221
    v_mov_b32 v5, v222
    s_nop 1
    v_permlane32_swap_b32 v222, v5
    v_max_f32 v222, v222, v5
    s_lshl_b32 s8, s70, 10
    s_add_u32 s8, s8, 0
    v_add_u32 v226, s8, v6
    s_lshl_b32 s9, s3, 8
    v_add_u32 v7, s9, v226
    ds_write_b32 v7, v222
    v_mov_b32 v5, v223
    s_nop 1
    v_permlane32_swap_b32 v223, v5
    v_max_f32 v223, v223, v5
    s_lshl_b32 s8, s71, 10
    s_add_u32 s8, s8, 0
    v_add_u32 v227, s8, v6
    s_lshl_b32 s9, s3, 8
    v_add_u32 v7, s9, v227
    ds_write_b32 v7, v223
    s_waitcnt lgkmcnt(0)
    s_mov_b64 exec, 1
    ds_add_u32 v14, v15 offset:76
    s_mov_b64 exec, -1
    s_mov_b32 s79, 262144
LW_25:
    ds_read_b32 v5, v14 offset:76
    s_waitcnt lgkmcnt(0)
    v_readfirstlane_b32 s78, v5
    s_nop 0
    s_cmp_ge_u32 s78, 4
    s_cbranch_scc1 LD_26
    s_sleep 1
    s_sub_u32 s79, s79, 1
    s_cmp_lg_u32 s79, 0
    s_cbranch_scc1 LW_25
LD_26:
    ds_read_b32 v112, v224 offset:0
    ds_read_b32 v113, v224 offset:256
    ds_read_b32 v114, v224 offset:512
    ds_read_b32 v115, v224 offset:768
    ds_read_b32 v116, v225 offset:0
    ds_read_b32 v117, v225 offset:256
    ds_read_b32 v118, v225 offset:512
    ds_read_b32 v119, v225 offset:768
    ds_read_b32 v120, v226 offset:0
    ds_read_b32 v121, v226 offset:256
    ds_read_b32 v122, v226 offset:512
    ds_read_b32 v123, v226 offset:768
    ds_read_b32 v124, v227 offset:0
    ds_read_b32 v125, v227 offset:256
    ds_read_b32 v126, v227 offset:512
    ds_read_b32 v127, v227 offset:768
    s_waitcnt lgkmcnt(0)
    s_mov_b64 exec, 1
    ds_add_u32 v14, v15 offset:76
    s_mov_b64 exec, -1
    v_max3_f32 v5, v112, v113, v114
    v_max_f32 v5, v5, v115
    v_sub_f32 v5, 0, v5
    v_cvt_pk_bf16_f32 v6, v5, v5
    v_and_b32 v7, 0xffff0000, v6
    v_sub_f32 v5, v5, v7
    v_cvt_pk_bf16_f32 v8, v5, v5
    v_and_b32 v7, 0xffff0000, v8
    v_sub_f32 v5, v5, v7
    v_cvt_pk_bf16_f32 v9, v5, 0
    v_and_b32 v6, 0xffff, v6
    v_or_b32 v6, v6, v7
    v_cndmask_b32 v22, v22, v6, s[74:75]
    v_cndmask_b32 v23, v23, v9, s[74:75]
    v_max3_f32 v5, v116, v117, v118
    v_max_f32 v5, v5, v119
    v_sub_f32 v5, 0, v5
    v_cvt_pk_bf16_f32 v6, v5, v5
    v_and_b32 v7, 0xffff0000, v6
    v_sub_f32 v5, v5, v7
    v_cvt_pk_bf16_f32 v8, v5, v5
    v_and_b32 v7, 0xffff0000, v8
    v_sub_f32 v5, v5, v7
    v_cvt_pk_bf16_f32 v9, v5, 0
    v_and_b32 v6, 0xffff, v6
    v_or_b32 v6, v6, v7
    v_cndmask_b32 v30, v30, v6, s[74:75]
    v_cndmask_b32 v31, v31, v9, s[74:75]
    v_max3_f32 v5, v120, v121, v122
    v_max_f32 v5, v5, v123
    v_sub_f32 v5, 0, v5
    v_cvt_pk_bf16_f32 v6, v5, v5
    v_and_b32 v7, 0xffff0000, v6
    v_sub_f32 v5, v5, v7
    v_cvt_pk_bf16_f32 v8, v5, v5
    v_and_b32 v7, 0xffff0000, v8
    v_sub_f32 v5, v5, v7
    v_cvt_pk_bf16_f32 v9, v5, 0
    v_and_b32 v6, 0xffff, v6
    v_or_b32 v6, v6, v7
    v_cndmask_b32 v38, v38, v6, s[74:75]
    v_cndmask_b32 v39, v39, v9, s[74:75]
    v_max3_f32 v5, v124, v125, v126
    v_max_f32 v5, v5, v127
    v_sub_f32 v5, 0, v5
    v_cvt_pk_bf16_f32 v6, v5, v5
    v_and_b32 v7, 0xffff0000, v6
    v_sub_f32 v5, v5, v7
    v_cvt_pk_bf16_f32 v8, v5, v5
    v_and_b32 v7, 0xffff0000, v8
    v_sub_f32 v5, v5, v7
    v_cvt_pk_bf16_f32 v9, v5, 0
    v_and_b32 v6, 0xffff, v6
    v_or_b32 v6, v6, v7
    v_cndmask_b32 v46, v46, v6, s[74:75]
    v_cndmask_b32 v47, v47, v9, s[74:75]
    v_mov_b32 v48, 0
    v_mov_b32 v49, 0
    v_mov_b32 v50, 0
    v_mov_b32 v51, 0
    v_mov_b32 v52, 0
    v_mov_b32 v53, 0
    v_mov_b32 v54, 0
    v_mov_b32 v55, 0
    v_mov_b32 v56, 0
    v_mov_b32 v57, 0
    v_mov_b32 v58, 0
    v_mov_b32 v59, 0
    v_mov_b32 v60, 0
    v_mov_b32 v61, 0
    v_mov_b32 v62, 0
    v_mov_b32 v63, 0
    v_mov_b32 v64, 0
    v_mov_b32 v65, 0
    v_mov_b32 v66, 0
    v_mov_b32 v67, 0
    v_mov_b32 v68, 0
    v_mov_b32 v69, 0
    v_mov_b32 v70, 0
    v_mov_b32 v71, 0
    v_mov_b32 v72, 0
    v_mov_b32 v73, 0
    v_mov_b32 v74, 0
    v_mov_b32 v75, 0
    v_mov_b32 v76, 0
    v_mov_b32 v77, 0
    v_mov_b32 v78, 0
    v_mov_b32 v79, 0
    v_mov_b32 v80, 0
    v_mov_b32 v81, 0
    v_mov_b32 v82, 0
    v_mov_b32 v83, 0
    v_mov_b32 v84, 0
    v_mov_b32 v85, 0
    v_mov_b32 v86, 0
    v_mov_b32 v87, 0
    v_mov_b32 v88, 0
    v_mov_b32 v89, 0
    v_mov_b32 v90, 0
    v_mov_b32 v91, 0
    v_mov_b32 v92, 0
    v_mov_b32 v93, 0
    v_mov_b32 v94, 0
    v_mov_b32 v95, 0
    v_mov_b32 v96, 0
    v_mov_b32 v97, 0
    v_mov_b32 v98, 0
    v_mov_b32 v99, 0
    v_mov_b32 v100, 0
    v_mov_b32 v101, 0
    v_mov_b32 v102, 0
    v_mov_b32 v103, 0
    v_mov_b32 v104, 0
    v_mov_b32 v105, 0
    v_mov_b32 v106, 0
    v_mov_b32 v107, 0
    v_mov_b32 v108, 0
    v_mov_b32 v109, 0
    v_mov_b32 v110, 0
    v_mov_b32 v111, 0
    v_mov_b32 v212, 0
    v_mov_b32 v148, 0
    v_mov_b32 v213, 0
    v_mov_b32 v149, 0
    v_mov_b32 v214, 0
    v_mov_b32 v150, 0
    v_mov_b32 v215, 0
    v_mov_b32 v151, 0
    s_mov_b32 s79, 262144
LW_27:
    ds_read_b32 v5, v14 offset:76
    s_waitcnt lgkmcnt(0)
    v_readfirstlane_b32 s78, v5
    s_nop 0
    s_cmp_ge_u32 s78, 8
    s_cbranch_scc1 LD_28
    s_sleep 1
    s_sub_u32 s79, s79, 1
    s_cmp_lg_u32 s79, 0
    s_cbranch_scc1 LW_27
LD_28:
    s_mov_b32 s4, 8
    s_lshl_b32 s15, s2, 9
    s_and_b32 s15, s15, 0xf000
    buffer_load_dwordx4 v[152:155], v4, s[56:59], s15 offen sc1
    buffer_load_dwordx4 v[156:159], v4, s[56:59], s15 offen offset:1024 sc1
    buffer_load_dwordx4 v[160:163], v4, s[56:59], s15 offen offset:2048 sc1
    buffer_load_dwordx4 v[164:167], v4, s[56:59], s15 offen offset:3072 sc1
    s_add_u32 s15, s15, 4096
    s_and_b32 s15, s15, 0xffff
    buffer_load_dwordx4 v[168:171], v4, s[56:59], s15 offen sc1
    buffer_load_dwordx4 v[172:175], v4, s[56:59], s15 offen offset:1024 sc1
    buffer_load_dwordx4 v[176:179], v4, s[56:59], s15 offen offset:2048 sc1
    buffer_load_dwordx4 v[180:183], v4, s[56:59], s15 offen offset:3072 sc1
    s_add_u32 s15, s15, 4096
    s_and_b32 s15, s15, 0xffff
    buffer_load_dwordx4 v[184:187], v4, s[56:59], s15 offen sc1
    buffer_load_dwordx4 v[188:191], v4, s[56:59], s15 offen offset:1024 sc1
    buffer_load_dwordx4 v[192:195], v4, s[56:59], s15 offen offset:2048 sc1
    buffer_load_dwordx4 v[196:199], v4, s[56:59], s15 offen offset:3072 sc1
    s_add_u32 s15, s15, 4096
    s_and_b32 s15, s15, 0xffff
    buffer_load_dwordx4 v[200:203], v4, s[56:59], s15 offen sc1
    buffer_load_dwordx4 v[204:207], v4, s[56:59], s15 offen offset:1024 sc1
    s_nop 1
    s_branch F_RESTART
F_AM:
    s_setprio 0
    s_cmp_eq_u32 s51, 7
    s_cbranch_scc1 F_A7
    s_lshl_b32 s8, s51, 6
    s_lshl_b32 s9, s5, 4
    s_add_u32 s9, s8, s9
    v_add_u32 v13, s9, v2
    v_lshlrev_b32 v30, 4, v13
    s_and_b32 s14, s5, 1
    s_lshr_b32 s15, s5, 1
    v_lshrrev_b32 v7, 3, v1
    v_add_u32 v7, s9, v7
    v_mul_u32_u24 v5, 896, v7
    v_and_b32 v6, 7, v1
    v_xor_b32 v6, v6, v3
    v_lshl_add_u32 v34, v6, 4, v5
    v_xor_b32 v6, 4, v6
    v_lshl_add_u32 v5, v6, 4, v5
    v_add_u32 v35, 7168, v5
    v_lshrrev_b32 v7, 3, v1
    v_add_u32 v7, s8, v7
    v_mul_u32_u24 v5, 896, v7
    v_and_b32 v6, 7, v1
    v_xor_b32 v6, v6, v3
    v_lshl_add_u32 v240, v6, 4, v5
    v_xor_b32 v6, 4, v6
    v_lshl_add_u32 v5, v6, 4, v5
    v_add_u32 v241, 7168, v5
    v_and_b32 v7, 32, v1
    v_bfe_u32 v6, v1, 3, 2
    s_lshl_b32 s12, s50, 6
    s_lshl_b32 s9, s5, 3
    s_add_u32 s9, s12, s9
    v_add3_u32 v7, v7, v6, s9
    v_mul_u32_u24 v5, 896, v7
    v_and_b32 v6, 7, v1
    v_xor_b32 v6, v6, v3
    v_lshl_add_u32 v32, v6, 4, v5
    v_xor_b32 v6, 4, v6
    v_lshl_add_u32 v5, v6, 4, v5
    v_add_u32 v33, 3584, v5
    v_and_b32 v5, 31, v1
    v_bfe_u32 v6, v5, 1, 3
    v_lshrrev_b32 v7, 5, v1
    v_xor_b32 v6, v6, v7
    v_lshlrev_b32 v6, 4, v6
    v_lshl_add_u32 v5, v5, 7, v6
    v_add_u32 v36, 86016, v5
    v_xor_b32 v37, 32, v36
    v_xor_b32 v38, 64, v36
    v_xor_b32 v39, 96, v36
    s_lshl_b32 s11, s5, 12
    s_lshl_b32 s10, s5, 11
    s_add_u32 s10, s10, 86016
    v_lshrrev_b32 v5, 3, v1
    s_mul_i32 s9, s5, 112
    v_add_u32 v5, s9, v5
    v_mul_u32_u24 v5, 896, v5
    v_and_b32 v7, 1, v3
    v_lshlrev_b32 v7, 2, v7
    v_and_b32 v6, 7, v1
    v_xor_b32 v7, v7, v6
    v_lshl_add_u32 v5, v7, 4, v5
    s_lshl_b32 s9, s51, 7
    v_add_u32 v242, s9, v5
    s_mul_i32 s9, s5, 5120
    s_add_u32 s9, s9, 65536
    v_mul_u32_u24 v5, 144, v2
    v_lshl_add_u32 v5, v3, 5, v5
    v_add_u32 v243, s9, v5
    v_lshrrev_b32 v5, 1, v3
    v_lshrrev_b32 v6, 2, v2
    v_lshl_add_u32 v5, v5, 3, v6
    v_mul_u32_u24 v5, 144, v5
    v_and_b32 v6, 1, v2
    v_lshl_add_u32 v5, v6, 6, v5
    v_and_b32 v6, 1, v3
    v_lshl_add_u32 v5, v6, 4, v5
    v_bfe_u32 v6, v2, 1, 1
    v_lshl_add_u32 v5, v6, 3, v5
    v_add_u32 v244, s9, v5
    v_min_u32 v5, 13, v1
    v_lshlrev_b32 v124, 6, v5
    s_lshl_b32 s9, s15, 10
    v_add_u32 v120, s9, v4
    v_xor_b32 v121, 1024, v120
    v_and_b32 v5, 32, v1
    s_lshl_b32 s9, s15, 4
    s_add_u32 s9, s12, s9
    v_add_u32 v5, s9, v5
    v_and_b32 v6, 31, v1
    s_lshl_b32 s9, s14, 5
    s_add_u32 s9, s8, s9
    v_add_u32 v6, s9, v6
    v_mul_u32_u24 v122, 3584, v5
    v_lshl_add_u32 v122, v6, 2, v122
    s_add_u32 s9, s51, 7
    s_sub_u32 s9, s9, s76
    s_sub_u32 s13, s9, 7
    s_cselect_b32 s9, s9, s13
    s_lshl_b32 s9, s9, 13
    s_lshl_b32 s13, s15, 12
    s_add_u32 s9, s9, s13
    s_add_u32 s9, s9, 86016
    v_bfe_u32 v5, v1, 3, 2
    s_lshl_b32 s13, s14, 2
    v_or_b32 v5, s13, v5
    v_lshrrev_b32 v6, 5, v1
    v_lshlrev_b32 v7, 1, v6
    v_xor_b32 v5, v5, v7
    v_lshlrev_b32 v5, 4, v5
    v_lshl_add_u32 v5, v6, 9, v5
    v_and_b32 v6, 7, v1
    v_lshl_add_u32 v5, v6, 1, v5
    v_add_u32 v123, s9, v5
    v_add_u32 v5, 1, v3
    v_mul_u32_u24 v5, 57344, v5
    v_sub_u32 v5, v30, v5
    s_mul_i32 s9, s50, 7168
    v_add_u32 v248, s9, v5
    v_add_u32 v249, 7168, v248
    v_add_u32 v250, 7168, v249
    v_add_u32 v251, 7168, v250
    v_add_u32 v252, 7168, v251
    v_add_u32 v253, 7168, v252
    v_add_u32 v254, 7168, v253
    v_add_u32 v255, 7168, v254
    v_cmp_le_i32 s[18:19], 0, v248
    v_cmp_le_i32 s[20:21], 0, v249
    v_cmp_le_i32 s[30:31], 0, v250
    v_cmp_le_i32 s[34:35], 0, v251
    v_cmp_le_i32 s[36:37], 0, v252
    v_cmp_le_i32 s[38:39], 0, v253
    v_cmp_le_i32 s[40:41], 0, v254
    v_cmp_le_i32 s[46:47], 0, v255
    v_lshlrev_b32 v125, 16, v125
    v_lshlrev_b32 v100, 16, v100
    v_lshlrev_b32 v101, 16, v101
    v_lshlrev_b32 v102, 16, v102
    v_mul_f32 v100, 0x3fb8aa3b, v100
    v_exp_f32 v100, v100
    s_nop 0
    v_cvt_pk_bf16_f32 v100, v100, v100
    v_lshlrev_b32 v100, 16, v100
    v_mul_f32 v103, v100, v101
    v_mul_f32 v104, v100, v102
    v_mul_f32 v103, 0x3fb8aa3b, v103
    v_mul_f32 v104, 0xbe22f983, v104
    v_exp_f32 v6, v103
    v_fract_f32 v17, v104
    v_cos_f32 v16, v17
    v_sin_f32 v17, v17
    v_mul_f32 v16, v6, v16
    v_mul_f32 v17, v6, v17
    v_mul_f32 v6, 0x41800000, v103
    v_mul_f32 v19, 0x41800000, v104
    v_exp_f32 v6, v6
    v_fract_f32 v19, v19
    v_cos_f32 v18, v19
    v_sin_f32 v19, v19
    v_mul_f32 v18, v6, v18
    v_mul_f32 v19, v6, v19
    v_mul_f32 v6, 0x42800000, v103
    v_mul_f32 v21, 0x42800000, v104
    v_exp_f32 v6, v6
    v_fract_f32 v21, v21
    v_cos_f32 v20, v21
    v_sin_f32 v21, v21
    v_mul_f32 v20, v6, v20
    v_mul_f32 v21, v6, v21
    v_lshlrev_b32 v7, 9, v3
    v_cvt_f32_u32 v7, v7
    v_mul_f32 v6, v7, v103
    v_mul_f32 v23, v7, v104
    v_exp_f32 v6, v6
    v_fract_f32 v23, v23
    v_cos_f32 v22, v23
    v_sin_f32 v23, v23
    v_mul_f32 v22, v6, v22
    v_mul_f32 v23, v6, v23
    v_add_f32 v6, -1.0, v16
    v_mul_f32 v7, v101, v101
    v_fma_f32 v7, v102, v102, v7
    v_rcp_f32 v7, v7
    v_mul_f32 v24, v6, v101
    v_fma_f32 v24, -v17, v102, v24
    v_mul_f32 v25, v6, v102
    v_fma_f32 v25, v17, v101, v25
    v_add_f32 v7, v7, v7
    v_mul_f32 v24, v24, v7
    v_mul_f32 v25, v25, v7
    v_mov_b32 v26, v25
    v_sub_f32 v27, 0, v24
    s_sub_u32 s9, s11, 86016
    v_add_u32 v8, s9, v36
    v_add_u32 v31, 0x10000, v8
    v_add_u32 v9, s9, v37
    v_add_u32 v245, 0x10000, v9
    v_add_u32 v10, s9, v38
    v_add_u32 v246, 0x10000, v10
    v_add_u32 v11, s9, v39
    v_add_u32 v247, 0x10000, v11
    s_lshl_b32 s9, s14, 6
    v_xor_b32 v12, s9, v240
    v_xor_b32 v13, s9, v241
    s_mov_b32 s52, s16
    s_mov_b32 s53, s17
    s_mov_b32 s54, 1835008
    s_mov_b32 s55, 0x00020000
    s_mov_b32 s56, s22
    s_mov_b32 s57, s23
    s_mov_b32 s58, 401408
    s_mov_b32 s59, 0x00020000
    s_mov_b32 s60, s24
    s_mov_b32 s61, s25
    s_mov_b32 s62, 401408
    s_mov_b32 s63, 0x00020000
    s_mov_b32 s79, 262144
LW_29:
    ds_read_b32 v5, v14 offset:28
    s_waitcnt lgkmcnt(0)
    v_readfirstlane_b32 s77, v5
    s_nop 0
    s_cmp_lg_u32 s77, 0
    s_cbranch_scc1 LD_30
    s_sleep 2
    s_sub_u32 s79, s79, 1
    s_cmp_lg_u32 s79, 0
    s_cbranch_scc1 LW_29
LD_30:
    s_setprio 1
    s_lshl_b32 s12, s76, 7
    s_mov_b32 s13, s12
    s_mul_i32 s74, s14, 28672
    s_sub_u32 s75, 28672, s74
    s_lshl_b32 s9, s14, 9
    s_add_u32 s72, s74, s9
    s_add_u32 s73, s75, s9
    s_mov_b32 s79, 262144
LW_31:
    ds_read_b32 v5, v14 offset:8
    s_waitcnt lgkmcnt(0)
    v_readfirstlane_b32 s78, v5
    s_nop 0
    s_cmp_ge_u32 s78, 4
    s_cbranch_scc1 LD_32
    s_sleep 1
    s_sub_u32 s79, s79, 1
    s_cmp_lg_u32 s79, 0
    s_cbranch_scc1 LW_31
LD_32:
    s_add_u32 m0, s10, 0
    s_waitcnt vmcnt(3)
    buffer_load_dwordx4 v32, s[52:55], s12 offen lds
    s_add_u32 m0, s10, 1024
    s_waitcnt vmcnt(3)
    buffer_load_dwordx4 v33, s[52:55], s12 offen lds
    s_add_u32 s12, s12, 128
    s_cmp_ge_u32 s12, 896
    s_cselect_b32 s12, 0, s12
    s_add_u32 m0, s11, 65536
    s_waitcnt vmcnt(3)
    buffer_load_dwordx4 v34, s[56:59], s13 offen lds
    s_add_u32 m0, s11, 66560
    s_waitcnt vmcnt(3)
    buffer_load_dwordx4 v35, s[56:59], s13 offen lds
    s_add_u32 m0, s11, 67584
    s_waitcnt vmcnt(3)
    buffer_load_dwordx4 v34, s[60:63], s13 offen lds
    s_add_u32 m0, s11, 68608
    s_waitcnt vmcnt(3)
    buffer_load_dwordx4 v35, s[60:63], s13 offen lds
    s_add_u32 s13, s13, 128
    s_cmp_ge_u32 s13, 896
    s_cselect_b32 s13, 0, s13
    s_add_u32 m0, s10, 8192
    s_waitcnt vmcnt(3)
    buffer_load_dwordx4 v32, s[52:55], s12 offen lds
    s_add_u32 m0, s10, 9216
    s_waitcnt vmcnt(3)
    buffer_load_dwordx4 v33, s[52:55], s12 offen lds
    s_add_u32 s12, s12, 128
    s_cmp_ge_u32 s12, 896
    s_cselect_b32 s12, 0, s12
    s_add_u32 m0, s11, 0
    s_waitcnt vmcnt(3)
    buffer_load_dwordx4 v34, s[56:59], s13 offen lds
    s_add_u32 m0, s11, 1024
    s_waitcnt vmcnt(3)
    buffer_load_dwordx4 v35, s[56:59], s13 offen lds
    s_add_u32 m0, s11, 2048
    s_waitcnt vmcnt(3)
    buffer_load_dwordx4 v34, s[60:63], s13 offen lds
    s_add_u32 m0, s11, 3072
    s_waitcnt vmcnt(3)
    buffer_load_dwordx4 v35, s[60:63], s13 offen lds
    s_add_u32 s13, s13, 128
    s_cmp_ge_u32 s13, 896
    s_cselect_b32 s13, 0, s13
    s_mov_b32 s79, 262144
LW_33:
    ds_read_b32 v5, v14 offset:12
    s_waitcnt lgkmcnt(0)
    v_readfirstlane_b32 s78, v5
    s_nop 0
    s_cmp_ge_u32 s78, 4
    s_cbranch_scc1 LD_34
    s_sleep 1
    s_sub_u32 s79, s79, 1
    s_cmp_lg_u32 s79, 0
    s_cbranch_scc1 LW_33
LD_34:
    s_add_u32 m0, s10, 16384
    s_waitcnt vmcnt(6)
    buffer_load_dwordx4 v32, s[52:55], s12 offen lds
    s_add_u32 m0, s10, 17408
    s_waitcnt vmcnt(6)
    buffer_load_dwordx4 v33, s[52:55], s12 offen lds
    s_add_u32 s12, s12, 128
    s_cmp_ge_u32 s12, 896
    s_cselect_b32 s12, 0, s12
    s_add_u32 m0, s11, 16384
    s_waitcnt vmcnt(6)
    buffer_load_dwordx4 v34, s[56:59], s13 offen lds
    s_add_u32 m0, s11, 17408
    s_waitcnt vmcnt(6)
    buffer_load_dwordx4 v35, s[56:59], s13 offen lds
    s_add_u32 m0, s11, 18432
    s_waitcnt vmcnt(6)
    buffer_load_dwordx4 v34, s[60:63], s13 offen lds
    s_add_u32 m0, s11, 19456
    s_waitcnt vmcnt(6)
    buffer_load_dwordx4 v35, s[60:63], s13 offen lds
    s_add_u32 s13, s13, 128
    s_cmp_ge_u32 s13, 896
    s_cselect_b32 s13, 0, s13
    s_waitcnt vmcnt(12)
    s_mov_b64 exec, 1
    ds_add_u32 v14, v15 offset:96
    s_mov_b64 exec, -1
    s_mov_b32 s79, 262144
LW_35:
    ds_read_b32 v5, v14 offset:96
    s_waitcnt lgkmcnt(0)
    v_readfirstlane_b32 s78, v5
    s_nop 0
    s_cmp_ge_u32 s78, 4
    s_cbranch_scc1 LD_36
    s_sleep 1
    s_sub_u32 s79, s79, 1
    s_cmp_lg_u32 s79, 0
    s_cbranch_scc1 LW_35
LD_36:
    ds_read_b128 v[72:75], v36 offset:0
    ds_read_b128 v[76:79], v36 offset:4096
    ds_read_b128 v[88:91], v31 offset:0
    ds_read_b128 v[80:83], v37 offset:0
    ds_read_b128 v[84:87], v37 offset:4096
    ds_read_b128 v[92:95], v245 offset:0
    ds_read_b128 v[96:99], v38 offset:0
    ds_read_b128 v[100:103], v38 offset:4096
    ds_read_b128 v[112:115], v246 offset:0
    ds_read_b128 v[104:107], v39 offset:0
    ds_read_b128 v[108:111], v39 offset:4096
    ds_read_b128 v[116:119], v247 offset:0
    s_waitcnt vmcnt(6)
    s_mov_b64 exec, 1
    ds_add_u32 v14, v15 offset:100
    s_mov_b64 exec, -1
    s_waitcnt lgkmcnt(7)
    v_mfma_f32_32x32x16_bf16 v[40:55], v[72:75], v[88:91], 0
    s_add_u32 m0, s10, 24576
    s_waitcnt vmcnt(6)
    buffer_load_dwordx4 v32, s[52:55], s12 offen lds
    v_mfma_f32_32x32x16_bf16 v[56:71], v[76:79], v[88:91], 0
    s_add_u32 m0, s10, 25600
    s_waitcnt vmcnt(6)
    buffer_load_dwordx4 v33, s[52:55], s12 offen lds
    s_add_u32 s12, s12, 128
    s_cmp_ge_u32 s12, 896
    s_cselect_b32 s12, 0, s12
    v_mfma_f32_32x32x16_bf16 v[40:55], v[80:83], v[92:95], v[40:55]
    s_add_u32 m0, s11, 32768
    s_waitcnt vmcnt(6)
    buffer_load_dwordx4 v34, s[56:59], s13 offen lds
    v_mfma_f32_32x32x16_bf16 v[56:71], v[84:87], v[92:95], v[56:71]
    s_add_u32 m0, s11, 33792
    s_waitcnt vmcnt(6)
    buffer_load_dwordx4 v35, s[56:59], s13 offen lds
    s_mov_b32 s79, 262144
LW_37:
    ds_read_b32 v5, v14 offset:100
    s_waitcnt lgkmcnt(0)
    v_readfirstlane_b32 s78, v5
    s_nop 0
    s_cmp_ge_u32 s78, 4
    s_cbranch_scc1 LD_38
    s_sleep 0
    s_sub_u32 s79, s79, 1
    s_cmp_lg_u32 s79, 0
    s_cbranch_scc1 LW_37
LD_38:
    ds_read_b128 v[72:75], v36 offset:8192
    ds_read_b128 v[76:79], v36 offset:12288
    ds_read_b128 v[88:91], v8 offset:0
    ds_read_b128 v[80:83], v37 offset:8192
    ds_read_b128 v[84:87], v37 offset:12288
    ds_read_b128 v[92:95], v9 offset:0
    v_mfma_f32_32x32x16_bf16 v[40:55], v[96:99], v[112:115], v[40:55]
    s_add_u32 m0, s11, 34816
    s_waitcnt vmcnt(6)
    buffer_load_dwordx4 v34, s[60:63], s13 offen lds
    v_mfma_f32_32x32x16_bf16 v[56:71], v[100:103], v[112:115], v[56:71]
    s_add_u32 m0, s11, 35840
    s_waitcnt vmcnt(6)
    buffer_load_dwordx4 v35, s[60:63], s13 offen lds
    s_add_u32 s13, s13, 128
    s_cmp_ge_u32 s13, 896
    s_cselect_b32 s13, 0, s13
    v_mfma_f32_32x32x16_bf16 v[40:55], v[104:107], v[116:119], v[40:55]
    v_mfma_f32_32x32x16_bf16 v[56:71], v[108:111], v[116:119], v[56:71]
    ds_read_b128 v[96:99], v38 offset:8192
    ds_read_b128 v[100:103], v38 offset:12288
    ds_read_b128 v[112:115], v10 offset:0
    ds_read_b128 v[104:107], v39 offset:8192
    ds_read_b128 v[108:111], v39 offset:12288
    ds_read_b128 v[116:119], v11 offset:0
    s_waitcnt vmcnt(6)
    v_nop
    v_nop
    s_mov_b64 exec, 1
    ds_add_u32 v14, v15 offset:104
    s_mov_b64 exec, -1
    s_waitcnt lgkmcnt(7)
    v_mfma_f32_32x32x16_bf16 v[40:55], v[72:75], v[88:91], v[40:55]
    s_add_u32 m0, s10, 32768
    s_waitcnt vmcnt(6)
    buffer_load_dwordx4 v32, s[52:55], s12 offen lds
    v_mfma_f32_32x32x16_bf16 v[56:71], v[76:79], v[88:91], v[56:71]
    s_add_u32 m0, s10, 33792
    s_waitcnt vmcnt(6)
    buffer_load_dwordx4 v33, s[52:55], s12 offen lds
    s_add_u32 s12, s12, 128
    s_cmp_ge_u32 s12, 896
    s_cselect_b32 s12, 0, s12
    v_mfma_f32_32x32x16_bf16 v[40:55], v[80:83], v[92:95], v[40:55]
    s_add_u32 m0, s11, 49152
    s_waitcnt vmcnt(6)
    buffer_load_dwordx4 v34, s[56:59], s13 offen lds
    v_mfma_f32_32x32x16_bf16 v[56:71], v[84:87], v[92:95], v[56:71]
    s_add_u32 m0, s11, 50176
    s_waitcnt vmcnt(6)
    buffer_load_dwordx4 v35, s[56:59], s13 offen lds
    s_mov_b32 s79, 262144
LW_39:
    ds_read_b32 v5, v14 offset:104
    s_waitcnt lgkmcnt(0)
    v_readfirstlane_b32 s78, v5
    s_nop 0
    s_cmp_ge_u32 s78, 4
    s_cbranch_scc1 LD_40
    s_sleep 0
    s_sub_u32 s79, s79, 1
    s_cmp_lg_u32 s79, 0
    s_cbranch_scc1 LW_39
LD_40:
    ds_read_b128 v[72:75], v36 offset:16384
    ds_read_b128 v[76:79], v36 offset:20480
    ds_read_b128 v[88:91], v8 offset:16384
    ds_read_b128 v[80:83], v37 offset:16384
    ds_read_b128 v[84:87], v37 offset:20480
    ds_read_b128 v[92:95], v9 offset:16384
    v_mfma_f32_32x32x16_bf16 v[40:55], v[96:99], v[112:115], v[40:55]
    s_add_u32 m0, s11, 51200
    s_waitcnt vmcnt(6)
    buffer_load_dwordx4 v34, s[60:63], s13 offen lds
    v_mfma_f32_32x32x16_bf16 v[56:71], v[100:103], v[112:115], v[56:71]
    s_add_u32 m0, s11, 52224
    s_waitcnt vmcnt(6)
    buffer_load_dwordx4 v35, s[60:63], s13 offen lds
    s_add_u32 s13, s13, 128
    s_cmp_ge_u32 s13, 896
    s_cselect_b32 s13, 0, s13
    v_mfma_f32_32x32x16_bf16 v[40:55], v[104:107], v[116:119], v[40:55]
    v_mfma_f32_32x32x16_bf16 v[56:71], v[108:111], v[116:119], v[56:71]
    ds_read_b128 v[96:99], v38 offset:16384
    ds_read_b128 v[100:103], v38 offset:20480
    ds_read_b128 v[112:115], v10 offset:16384
    ds_read_b128 v[104:107], v39 offset:16384
    ds_read_b128 v[108:111], v39 offset:20480
    ds_read_b128 v[116:119], v11 offset:16384
    s_waitcnt vmcnt(6)
    v_nop
    v_nop
    s_mov_b64 exec, 1
    ds_add_u32 v14, v15 offset:108
    s_mov_b64 exec, -1
    s_waitcnt lgkmcnt(7)
    v_mfma_f32_32x32x16_bf16 v[40:55], v[72:75], v[88:91], v[40:55]
    s_add_u32 m0, s10, 40960
    s_waitcnt vmcnt(6)
    buffer_load_dwordx4 v32, s[52:55], s12 offen lds
    v_mfma_f32_32x32x16_bf16 v[56:71], v[76:79], v[88:91], v[56:71]
    s_add_u32 m0, s10, 41984
    s_waitcnt vmcnt(6)
    buffer_load_dwordx4 v33, s[52:55], s12 offen lds
    s_add_u32 s12, s12, 128
    s_cmp_ge_u32 s12, 896
    s_cselect_b32 s12, 0, s12
    v_mfma_f32_32x32x16_bf16 v[40:55], v[80:83], v[92:95], v[40:55]
    s_add_u32 m0, s11, 65536
    s_waitcnt vmcnt(6)
    buffer_load_dwordx4 v34, s[56:59], s13 offen lds
    v_mfma_f32_32x32x16_bf16 v[56:71], v[84:87], v[92:95], v[56:71]
    s_add_u32 m0, s11, 66560
    s_waitcnt vmcnt(6)
    buffer_load_dwordx4 v35, s[56:59], s13 offen lds
    s_mov_b32 s79, 262144
LW_41:
    ds_read_b32 v5, v14 offset:108
    s_waitcnt lgkmcnt(0)
    v_readfirstlane_b32 s78, v5
    s_nop 0
    s_cmp_ge_u32 s78, 4
    s_cbranch_scc1 LD_42
    s_sleep 0
    s_sub_u32 s79, s79, 1
    s_cmp_lg_u32 s79, 0
    s_cbranch_scc1 LW_41
LD_42:
    ds_read_b128 v[72:75], v36 offset:24576
    ds_read_b128 v[76:79], v36 offset:28672
    ds_read_b128 v[88:91], v8 offset:32768
    ds_read_b128 v[80:83], v37 offset:24576
    ds_read_b128 v[84:87], v37 offset:28672
    ds_read_b128 v[92:95], v9 offset:32768
    v_mfma_f32_32x32x16_bf16 v[40:55], v[96:99], v[112:115], v[40:55]
    s_add_u32 m0, s11, 67584
    s_waitcnt vmcnt(6)
    buffer_load_dwordx4 v34, s[60:63], s13 offen lds
    v_mfma_f32_32x32x16_bf16 v[56:71], v[100:103], v[112:115], v[56:71]
    s_add_u32 m0, s11, 68608
    s_waitcnt vmcnt(6)
    buffer_load_dwordx4 v35, s[60:63], s13 offen lds
    s_add_u32 s13, s13, 128
    s_cmp_ge_u32 s13, 896
    s_cselect_b32 s13, 0, s13
    v_mfma_f32_32x32x16_bf16 v[40:55], v[104:107], v[116:119], v[40:55]
    v_mfma_f32_32x32x16_bf16 v[56:71], v[108:111], v[116:119], v[56:71]
    ds_read_b128 v[96:99], v38 offset:24576
    ds_read_b128 v[100:103], v38 offset:28672
    ds_read_b128 v[112:115], v10 offset:32768
    ds_read_b128 v[104:107], v39 offset:24576
    ds_read_b128 v[108:111], v39 offset:28672
    ds_read_b128 v[116:119], v11 offset:32768
    s_waitcnt vmcnt(6)
    v_nop
    v_nop
    s_mov_b64 exec, 1
    ds_add_u32 v14, v15 offset:112
    s_mov_b64 exec, -1
    s_waitcnt lgkmcnt(7)
    v_mfma_f32_32x32x16_bf16 v[40:55], v[72:75], v[88:91], v[40:55]
    s_add_u32 m0, s10, 49152
    s_waitcnt vmcnt(6)
    buffer_load_dwordx4 v32, s[52:55], s12 offen lds
    v_mfma_f32_32x32x16_bf16 v[56:71], v[76:79], v[88:91], v[56:71]
    s_add_u32 m0, s10, 50176
    s_waitcnt vmcnt(6)
    buffer_load_dwordx4 v33, s[52:55], s12 offen lds
    s_add_u32 s12, s12, 128
    s_cmp_ge_u32 s12, 896
    s_cselect_b32 s12, 0, s12
    v_mfma_f32_32x32x16_bf16 v[40:55], v[80:83], v[92:95], v[40:55]
    s_add_u32 m0, s11, 0
    s_waitcnt vmcnt(6)
    buffer_load_dwordx4 v34, s[56:59], s13 offen lds
    v_mfma_f32_32x32x16_bf16 v[56:71], v[84:87], v[92:95], v[56:71]
    s_add_u32 m0, s11, 1024
    s_waitcnt vmcnt(6)
    buffer_load_dwordx4 v35, s[56:59], s13 offen lds
    s_mov_b32 s79, 262144
LW_43:
    ds_read_b32 v5, v14 offset:112
    s_waitcnt lgkmcnt(0)
    v_readfirstlane_b32 s78, v5
    s_nop 0
    s_cmp_ge_u32 s78, 4
    s_cbranch_scc1 LD_44
    s_sleep 0
    s_sub_u32 s79, s79, 1
    s_cmp_lg_u32 s79, 0
    s_cbranch_scc1 LW_43
LD_44:
    ds_read_b128 v[72:75], v36 offset:32768
    ds_read_b128 v[76:79], v36 offset:36864
    ds_read_b128 v[88:91], v8 offset:49152
    ds_read_b128 v[80:83], v37 offset:32768
    ds_read_b128 v[84:87], v37 offset:36864
    ds_read_b128 v[92:95], v9 offset:49152
    v_mfma_f32_32x32x16_bf16 v[40:55], v[96:99], v[112:115], v[40:55]
    s_add_u32 m0, s11, 2048
    s_waitcnt vmcnt(6)
    buffer_load_dwordx4 v34, s[60:63], s13 offen lds
    v_mfma_f32_32x32x16_bf16 v[56:71], v[100:103], v[112:115], v[56:71]
    s_add_u32 m0, s11, 3072
    s_waitcnt vmcnt(6)
    buffer_load_dwordx4 v35, s[60:63], s13 offen lds
    s_add_u32 s13, s13, 128
    s_cmp_ge_u32 s13, 896
    s_cselect_b32 s13, 0, s13
    v_mfma_f32_32x32x16_bf16 v[40:55], v[104:107], v[116:119], v[40:55]
    v_mfma_f32_32x32x16_bf16 v[56:71], v[108:111], v[116:119], v[56:71]
    ds_read_b128 v[96:99], v38 offset:32768
    ds_read_b128 v[100:103], v38 offset:36864
    ds_read_b128 v[112:115], v10 offset:49152
    ds_read_b128 v[104:107], v39 offset:32768
    ds_read_b128 v[108:111], v39 offset:36864
    ds_read_b128 v[116:119], v11 offset:49152
    s_waitcnt vmcnt(6)
    v_nop
    v_nop
    s_mov_b64 exec, 1
    ds_add_u32 v14, v15 offset:116
    s_mov_b64 exec, -1
    s_waitcnt lgkmcnt(7)
    v_mfma_f32_32x32x16_bf16 v[40:55], v[72:75], v[88:91], v[40:55]
    s_mov_b32 s68, s26
    s_mov_b32 s69, s27
    s_mov_b32 s70, 401408
    s_mov_b32 s71, 0x00020000
    buffer_load_dword v126, v0, s[68:71], 0 offen
    v_mfma_f32_32x32x16_bf16 v[56:71], v[76:79], v[88:91], v[56:71]
    s_mov_b32 s68, s28
    s_mov_b32 s69, s29
    s_mov_b32 s70, 401408
    s_mov_b32 s71, 0x00020000
    buffer_load_dword v127, v0, s[68:71], 0 offen
    v_mfma_f32_32x32x16_bf16 v[40:55], v[80:83], v[92:95], v[40:55]
    s_cmp_lt_u32 s5, 2
    s_cselect_b32 s56, s26, s28
    s_cselect_b32 s57, s27, s29
    v_mfma_f32_32x32x16_bf16 v[56:71], v[84:87], v[92:95], v[56:71]
    s_mov_b32 s79, 262144
LW_45:
    ds_read_b32 v5, v14 offset:116
    s_waitcnt lgkmcnt(0)
    v_readfirstlane_b32 s78, v5
    s_nop 0
    s_cmp_ge_u32 s78, 4
    s_cbranch_scc1 LD_46
    s_sleep 0
    s_sub_u32 s79, s79, 1
    s_cmp_lg_u32 s79, 0
    s_cbranch_scc1 LW_45
LD_46:
    ds_read_b128 v[72:75], v36 offset:40960
    ds_read_b128 v[76:79], v36 offset:45056
    ds_read_b128 v[88:91], v31 offset:0
    ds_read_b128 v[80:83], v37 offset:40960
    ds_read_b128 v[84:87], v37 offset:45056
    ds_read_b128 v[92:95], v245 offset:0
    v_mfma_f32_32x32x16_bf16 v[40:55], v[96:99], v[112:115], v[40:55]
    v_mfma_f32_32x32x16_bf16 v[56:71], v[100:103], v[112:115], v[56:71]
    v_mfma_f32_32x32x16_bf16 v[40:55], v[104:107], v[116:119], v[40:55]
    v_mfma_f32_32x32x16_bf16 v[56:71], v[108:111], v[116:119], v[56:71]
    ds_read_b128 v[96:99], v38 offset:40960
    ds_read_b128 v[100:103], v38 offset:45056
    ds_read_b128 v[112:115], v246 offset:0
    ds_read_b128 v[104:107], v39 offset:40960
    ds_read_b128 v[108:111], v39 offset:45056
    ds_read_b128 v[116:119], v247 offset:0
    s_waitcnt vmcnt(2)
    v_nop
    v_nop
    s_mov_b64 exec, 1
    ds_add_u32 v14, v15 offset:120
    s_mov_b64 exec, -1
    s_waitcnt lgkmcnt(7)
    v_mfma_f32_32x32x16_bf16 v[40:55], v[72:75], v[88:91], v[40:55]
    s_add_u32 m0, s11, 16384
    s_add_u32 s12, s72, 0
    s_waitcnt vmcnt(6)
    buffer_load_dwordx4 v240, s[56:59], s12 offen lds
    v_mfma_f32_32x32x16_bf16 v[56:71], v[76:79], v[88:91], v[56:71]
    s_add_u32 m0, s11, 17408
    s_add_u32 s12, s72, 0
    s_waitcnt vmcnt(6)
    buffer_load_dwordx4 v241, s[56:59], s12 offen lds
    v_mfma_f32_32x32x16_bf16 v[40:55], v[80:83], v[92:95], v[40:55]
    s_add_u32 m0, s11, 18432
    s_add_u32 s12, s72, 14336
    s_waitcnt vmcnt(6)
    buffer_load_dwordx4 v240, s[56:59], s12 offen lds
    v_mfma_f32_32x32x16_bf16 v[56:71], v[84:87], v[92:95], v[56:71]
    s_add_u32 m0, s11, 19456
    s_add_u32 s12, s72, 14336
    s_waitcnt vmcnt(6)
    buffer_load_dwordx4 v241, s[56:59], s12 offen lds
    s_mov_b32 s79, 262144
LW_47:
    ds_read_b32 v5, v14 offset:120
    s_waitcnt lgkmcnt(0)
    v_readfirstlane_b32 s78, v5
    s_nop 0
    s_cmp_ge_u32 s78, 4
    s_cbranch_scc1 LD_48
    s_sleep 0
    s_sub_u32 s79, s79, 1
    s_cmp_lg_u32 s79, 0
    s_cbranch_scc1 LW_47
LD_48:
    ds_read_b128 v[72:75], v36 offset:49152
    ds_read_b128 v[76:79], v36 offset:53248
    ds_read_b128 v[88:91], v8 offset:0
    ds_read_b128 v[80:83], v37 offset:49152
    ds_read_b128 v[84:87], v37 offset:53248
    ds_read_b128 v[92:95], v9 offset:0
    v_mfma_f32_32x32x16_bf16 v[40:55], v[96:99], v[112:115], v[40:55]
    v_mfma_f32_32x32x16_bf16 v[56:71], v[100:103], v[112:115], v[56:71]
    v_mfma_f32_32x32x16_bf16 v[40:55], v[104:107], v[116:119], v[40:55]
    v_mfma_f32_32x32x16_bf16 v[56:71], v[108:111], v[116:119], v[56:71]
    ds_read_b128 v[96:99], v38 offset:49152
    ds_read_b128 v[100:103], v38 offset:53248
    ds_read_b128 v[112:115], v10 offset:0
    ds_read_b128 v[104:107], v39 offset:49152
    ds_read_b128 v[108:111], v39 offset:53248
    ds_read_b128 v[116:119], v11 offset:0
    s_waitcnt lgkmcnt(6)
    v_mfma_f32_32x32x16_bf16 v[40:55], v[72:75], v[88:91], v[40:55]
    s_add_u32 m0, s11, 32768
    s_add_u32 s12, s73, 0
    s_waitcnt vmcnt(6)
    buffer_load_dwordx4 v240, s[56:59], s12 offen lds
    v_mfma_f32_32x32x16_bf16 v[56:71], v[76:79], v[88:91], v[56:71]
    s_add_u32 m0, s11, 33792
    s_add_u32 s12, s73, 0
    s_waitcnt vmcnt(6)
    buffer_load_dwordx4 v241, s[56:59], s12 offen lds
    v_mfma_f32_32x32x16_bf16 v[40:55], v[80:83], v[92:95], v[40:55]
    s_add_u32 m0, s11, 34816
    s_add_u32 s12, s73, 14336
    s_waitcnt vmcnt(6)
    buffer_load_dwordx4 v240, s[56:59], s12 offen lds
    v_mfma_f32_32x32x16_bf16 v[56:71], v[84:87], v[92:95], v[56:71]
    s_add_u32 m0, s11, 35840
    s_add_u32 s12, s73, 14336
    s_waitcnt vmcnt(6)
    buffer_load_dwordx4 v241, s[56:59], s12 offen lds
    s_waitcnt lgkmcnt(0)
    v_mfma_f32_32x32x16_bf16 v[40:55], v[96:99], v[112:115], v[40:55]
    s_mov_b32 s68, s42
    s_mov_b32 s69, s43
    s_mov_b32 s70, 401408
    s_mov_b32 s71, 0x00020000
    buffer_load_dword v126, v0, s[68:71], 0 offen
    v_mfma_f32_32x32x16_bf16 v[56:71], v[100:103], v[112:115], v[56:71]
    v_mfma_f32_32x32x16_bf16 v[40:55], v[104:107], v[116:119], v[40:55]
    v_mfma_f32_32x32x16_bf16 v[56:71], v[108:111], v[116:119], v[56:71]
    v_xor_b32 v5, 16, v123
    v_xor_b32 v6, 64, v123
    v_xor_b32 v7, 80, v123
    ds_read_u16 v72, v123 offset:0
    ds_read_u16 v73, v123 offset:128
    ds_read_u16 v74, v5 offset:256
    ds_read_u16 v75, v5 offset:384
    ds_read_u16 v76, v6 offset:1024
    ds_read_u16 v77, v6 offset:1152
    ds_read_u16 v78, v7 offset:1280
    ds_read_u16 v79, v7 offset:1408
    ds_read_u16 v80, v123 offset:2048
    ds_read_u16 v81, v123 offset:2176
    ds_read_u16 v82, v5 offset:2304
    ds_read_u16 v83, v5 offset:2432
    ds_read_u16 v84, v6 offset:3072
    ds_read_u16 v85, v6 offset:3200
    ds_read_u16 v86, v7 offset:3328
    ds_read_u16 v87, v7 offset:3456
    s_mov_b32 s52, s42
    s_mov_b32 s53, s43
    s_mov_b32 s54, 401408
    s_mov_b32 s55, 0x00020000
    s_mul_i32 s10, s5, 14336
    s_add_u32 s10, s10, 98304
    s_waitcnt lgkmcnt(0)
    s_mov_b64 exec, 1
    ds_add_u32 v14, v15 offset:64
    s_mov_b64 exec, -1
    v_lshl_or_b32 v116, v73, 16, v72
    v_lshl_or_b32 v117, v75, 16, v74
    v_lshl_or_b32 v118, v77, 16, v76
    v_lshl_or_b32 v119, v79, 16, v78
    v_lshl_or_b32 v245, v81, 16, v80
    v_lshl_or_b32 v246, v83, 16, v82
    v_lshl_or_b32 v247, v85, 16, v84
    v_lshl_or_b32 v31, v87, 16, v86
    s_add_u32 m0, s11, 49152
    s_add_u32 s12, s72, 128
    s_waitcnt vmcnt(6)
    buffer_load_dwordx4 v240, s[56:59], s12 offen lds
    s_add_u32 m0, s11, 50176
    s_add_u32 s12, s72, 128
    s_waitcnt vmcnt(6)
    buffer_load_dwordx4 v241, s[56:59], s12 offen lds
    s_add_u32 m0, s11, 51200
    s_add_u32 s12, s72, 14464
    s_waitcnt vmcnt(6)
    buffer_load_dwordx4 v240, s[56:59], s12 offen lds
    s_setprio 3
    v_permlane16_swap_b32 v40, v56
    v_permlane16_swap_b32 v41, v57
    v_permlane16_swap_b32 v42, v58
    v_permlane16_swap_b32 v43, v59
    v_permlane16_swap_b32 v44, v60
    v_permlane16_swap_b32 v45, v61
    v_permlane16_swap_b32 v46, v62
    v_permlane16_swap_b32 v47, v63
    v_permlane16_swap_b32 v48, v64
    v_permlane16_swap_b32 v49, v65
    v_permlane16_swap_b32 v50, v66
    v_permlane16_swap_b32 v51, v67
    v_permlane16_swap_b32 v52, v68
    v_permlane16_swap_b32 v53, v69
    v_permlane16_swap_b32 v54, v70
    v_permlane16_swap_b32 v55, v71
    v_pk_mul_f32 v[72:73], v[24:25], v[40:41] op_sel:[0,0] op_sel_hi:[1,0]
    v_pk_fma_f32 v[72:73], v[26:27], v[56:57], v[72:73] op_sel:[0,0,0] op_sel_hi:[1,0,1]
    v_pk_mul_f32 v[74:75], v[40:41], v[24:25] op_sel:[1,0] op_sel_hi:[1,1]
    v_pk_fma_f32 v[74:75], v[56:57], v[26:27], v[74:75] op_sel:[1,0,0] op_sel_hi:[1,1,1]
    v_pk_mul_f32 v[76:77], v[24:25], v[42:43] op_sel:[0,0] op_sel_hi:[1,0]
    v_pk_fma_f32 v[76:77], v[26:27], v[58:59], v[76:77] op_sel:[0,0,0] op_sel_hi:[1,0,1]
    v_pk_fma_f32 v[6:7], v[16:17], v[72:73], v[74:75] op_sel:[1,1,0] op_sel_hi:[1,0,1] neg_lo:[1,0,0]
    v_pk_fma_f32 v[28:29], v[16:17], v[72:73], v[6:7] op_sel_hi:[0,1,1]
    v_pk_mul_f32 v[78:79], v[42:43], v[24:25] op_sel:[1,0] op_sel_hi:[1,1]
    v_pk_fma_f32 v[78:79], v[58:59], v[26:27], v[78:79] op_sel:[1,0,0] op_sel_hi:[1,1,1]
    v_pk_fma_f32 v[6:7], v[16:17], v[28:29], v[76:77] op_sel:[1,1,0] op_sel_hi:[1,0,1] neg_lo:[1,0,0]
    v_pk_fma_f32 v[28:29], v[16:17], v[28:29], v[6:7] op_sel_hi:[0,1,1]
    s_add_u32 m0, s11, 52224
    s_add_u32 s12, s72, 14464
    s_waitcnt vmcnt(6)
    buffer_load_dwordx4 v241, s[56:59], s12 offen lds
    v_pk_mul_f32 v[80:81], v[24:25], v[44:45] op_sel:[0,0] op_sel_hi:[1,0]
    v_pk_fma_f32 v[80:81], v[26:27], v[60:61], v[80:81] op_sel:[0,0,0] op_sel_hi:[1,0,1]
    v_pk_fma_f32 v[6:7], v[16:17], v[28:29], v[78:79] op_sel:[1,1,0] op_sel_hi:[1,0,1] neg_lo:[1,0,0]
    v_pk_fma_f32 v[28:29], v[16:17], v[28:29], v[6:7] op_sel_hi:[0,1,1]
    v_pk_mul_f32 v[82:83], v[44:45], v[24:25] op_sel:[1,0] op_sel_hi:[1,1]
    v_pk_fma_f32 v[82:83], v[60:61], v[26:27], v[82:83] op_sel:[1,0,0] op_sel_hi:[1,1,1]
    v_pk_fma_f32 v[6:7], v[16:17], v[28:29], v[80:81] op_sel:[1,1,0] op_sel_hi:[1,0,1] neg_lo:[1,0,0]
    v_pk_fma_f32 v[28:29], v[16:17], v[28:29], v[6:7] op_sel_hi:[0,1,1]
    v_pk_mul_f32 v[84:85], v[24:25], v[46:47] op_sel:[0,0] op_sel_hi:[1,0]
    v_pk_fma_f32 v[84:85], v[26:27], v[62:63], v[84:85] op_sel:[0,0,0] op_sel_hi:[1,0,1]
    v_pk_fma_f32 v[6:7], v[16:17], v[28:29], v[82:83] op_sel:[1,1,0] op_sel_hi:[1,0,1] neg_lo:[1,0,0]
    v_pk_fma_f32 v[28:29], v[16:17], v[28:29], v[6:7] op_sel_hi:[0,1,1]
    v_pk_mul_f32 v[86:87], v[46:47], v[24:25] op_sel:[1,0] op_sel_hi:[1,1]
    v_pk_fma_f32 v[86:87], v[62:63], v[26:27], v[86:87] op_sel:[1,0,0] op_sel_hi:[1,1,1]
    v_pk_fma_f32 v[6:7], v[16:17], v[28:29], v[84:85] op_sel:[1,1,0] op_sel_hi:[1,0,1] neg_lo:[1,0,0]
    v_pk_fma_f32 v[28:29], v[16:17], v[28:29], v[6:7] op_sel_hi:[0,1,1]
    s_add_u32 m0, s11, 0
    s_add_u32 s12, s73, 128
    s_waitcnt vmcnt(6)
    buffer_load_dwordx4 v240, s[56:59], s12 offen lds
    v_pk_mul_f32 v[88:89], v[24:25], v[48:49] op_sel:[0,0] op_sel_hi:[1,0]
    v_pk_fma_f32 v[88:89], v[26:27], v[64:65], v[88:89] op_sel:[0,0,0] op_sel_hi:[1,0,1]
    v_pk_fma_f32 v[6:7], v[16:17], v[28:29], v[86:87] op_sel:[1,1,0] op_sel_hi:[1,0,1] neg_lo:[1,0,0]
    v_pk_fma_f32 v[28:29], v[16:17], v[28:29], v[6:7] op_sel_hi:[0,1,1]
    v_pk_mul_f32 v[90:91], v[48:49], v[24:25] op_sel:[1,0] op_sel_hi:[1,1]
    v_pk_fma_f32 v[90:91], v[64:65], v[26:27], v[90:91] op_sel:[1,0,0] op_sel_hi:[1,1,1]
    v_pk_fma_f32 v[6:7], v[16:17], v[28:29], v[88:89] op_sel:[1,1,0] op_sel_hi:[1,0,1] neg_lo:[1,0,0]
    v_pk_fma_f32 v[28:29], v[16:17], v[28:29], v[6:7] op_sel_hi:[0,1,1]
    v_pk_mul_f32 v[92:93], v[24:25], v[50:51] op_sel:[0,0] op_sel_hi:[1,0]
    v_pk_fma_f32 v[92:93], v[26:27], v[66:67], v[92:93] op_sel:[0,0,0] op_sel_hi:[1,0,1]
    v_pk_fma_f32 v[6:7], v[16:17], v[28:29], v[90:91] op_sel:[1,1,0] op_sel_hi:[1,0,1] neg_lo:[1,0,0]
    v_pk_fma_f32 v[28:29], v[16:17], v[28:29], v[6:7] op_sel_hi:[0,1,1]
    v_pk_mul_f32 v[94:95], v[50:51], v[24:25] op_sel:[1,0] op_sel_hi:[1,1]
    v_pk_fma_f32 v[94:95], v[66:67], v[26:27], v[94:95] op_sel:[1,0,0] op_sel_hi:[1,1,1]
    v_pk_fma_f32 v[6:7], v[16:17], v[28:29], v[92:93] op_sel:[1,1,0] op_sel_hi:[1,0,1] neg_lo:[1,0,0]
    v_pk_fma_f32 v[28:29], v[16:17], v[28:29], v[6:7] op_sel_hi:[0,1,1]
    s_add_u32 m0, s11, 1024
    s_add_u32 s12, s73, 128
    s_waitcnt vmcnt(6)
    buffer_load_dwordx4 v241, s[56:59], s12 offen lds
    v_pk_mul_f32 v[96:97], v[24:25], v[52:53] op_sel:[0,0] op_sel_hi:[1,0]
    v_pk_fma_f32 v[96:97], v[26:27], v[68:69], v[96:97] op_sel:[0,0,0] op_sel_hi:[1,0,1]
    v_pk_fma_f32 v[6:7], v[16:17], v[28:29], v[94:95] op_sel:[1,1,0] op_sel_hi:[1,0,1] neg_lo:[1,0,0]
    v_pk_fma_f32 v[28:29], v[16:17], v[28:29], v[6:7] op_sel_hi:[0,1,1]
    v_pk_mul_f32 v[98:99], v[52:53], v[24:25] op_sel:[1,0] op_sel_hi:[1,1]
    v_pk_fma_f32 v[98:99], v[68:69], v[26:27], v[98:99] op_sel:[1,0,0] op_sel_hi:[1,1,1]
    v_pk_fma_f32 v[6:7], v[16:17], v[28:29], v[96:97] op_sel:[1,1,0] op_sel_hi:[1,0,1] neg_lo:[1,0,0]
    v_pk_fma_f32 v[28:29], v[16:17], v[28:29], v[6:7] op_sel_hi:[0,1,1]
    v_pk_mul_f32 v[100:101], v[24:25], v[54:55] op_sel:[0,0] op_sel_hi:[1,0]
    v_pk_fma_f32 v[100:101], v[26:27], v[70:71], v[100:101] op_sel:[0,0,0] op_sel_hi:[1,0,1]
    v_pk_fma_f32 v[6:7], v[16:17], v[28:29], v[98:99] op_sel:[1,1,0] op_sel_hi:[1,0,1] neg_lo:[1,0,0]
    v_pk_fma_f32 v[28:29], v[16:17], v[28:29], v[6:7] op_sel_hi:[0,1,1]
    v_pk_mul_f32 v[102:103], v[54:55], v[24:25] op_sel:[1,0] op_sel_hi:[1,1]
    v_pk_fma_f32 v[102:103], v[70:71], v[26:27], v[102:103] op_sel:[1,0,0] op_sel_hi:[1,1,1]
    v_pk_fma_f32 v[6:7], v[16:17], v[28:29], v[100:101] op_sel:[1,1,0] op_sel_hi:[1,0,1] neg_lo:[1,0,0]
    v_pk_fma_f32 v[28:29], v[16:17], v[28:29], v[6:7] op_sel_hi:[0,1,1]
    v_pk_fma_f32 v[6:7], v[16:17], v[28:29], v[102:103] op_sel:[1,1,0] op_sel_hi:[1,0,1] neg_lo:[1,0,0]
    v_pk_fma_f32 v[28:29], v[16:17], v[28:29], v[6:7] op_sel_hi:[0,1,1]
    s_lshl_b32 s8, s5, 9
    s_add_u32 s8, s8, 161536
    v_lshl_add_u32 v5, v1, 3, s8
    ds_write_b64 v5, v[28:29]
    v_lshl_add_u32 v5, v2, 3, s8
    ds_read_b64 v[104:105], v5 offset:0
    ds_read_b64 v[106:107], v5 offset:128
    ds_read_b64 v[108:109], v5 offset:256
    ds_read_b64 v[110:111], v5 offset:384
    s_add_u32 s60, s48, 3407872
    s_addc_u32 s61, s49, 0
    s_mov_b32 s62, 229376
    s_mov_b32 s63, 0x00020000
    s_mul_i32 s8, s50, 7168
    v_mov_b32 v115, s77
    s_waitcnt lgkmcnt(0)
    v_pk_fma_f32 v[6:7], v[18:19], v[104:105], v[106:107] op_sel:[1,1,0] op_sel_hi:[1,0,1] neg_lo:[1,0,0]
    v_pk_fma_f32 v[112:113], v[18:19], v[104:105], v[6:7] op_sel_hi:[0,1,1]
    v_pk_fma_f32 v[6:7], v[18:19], v[112:113], v[108:109] op_sel:[1,1,0] op_sel_hi:[1,0,1] neg_lo:[1,0,0]
    v_pk_fma_f32 v[112:113], v[18:19], v[112:113], v[6:7] op_sel_hi:[0,1,1]
    v_pk_fma_f32 v[6:7], v[18:19], v[112:113], v[110:111] op_sel:[1,1,0] op_sel_hi:[1,0,1] neg_lo:[1,0,0]
    v_pk_fma_f32 v[112:113], v[18:19], v[112:113], v[6:7] op_sel_hi:[0,1,1]
    v_mov_b32 v114, v113
    v_mov_b32 v113, s77
    s_mov_b64 exec, 0xffff
    buffer_store_dwordx4 v[112:115], v30, s[60:63], s8 offen sc1
    s_mov_b64 exec, -1
    s_setprio 1
    s_add_u32 m0, s11, 2048
    s_add_u32 s12, s73, 14464
    s_waitcnt vmcnt(6)
    buffer_load_dwordx4 v240, s[56:59], s12 offen lds
    s_add_u32 m0, s11, 3072
    s_add_u32 s12, s73, 14464
    s_waitcnt vmcnt(6)
    buffer_load_dwordx4 v241, s[56:59], s12 offen lds
    s_mov_b32 s79, 262144
LW_49:
    ds_read_b32 v5, v14 offset:64
    s_waitcnt lgkmcnt(0)
    v_readfirstlane_b32 s78, v5
    s_nop 0
    s_cmp_ge_u32 s78, 4
    s_cbranch_scc1 LD_50
    s_sleep 1
    s_sub_u32 s79, s79, 1
    s_cmp_lg_u32 s79, 0
    s_cbranch_scc1 LW_49
LD_50:
    s_mov_b32 s79, 262144
LW_51:
    ds_read_b32 v5, v14 offset:20
    s_waitcnt lgkmcnt(0)
    v_readfirstlane_b32 s78, v5
    s_nop 0
    s_cmp_ge_u32 s78, 4
    s_cbranch_scc1 LD_52
    s_sleep 1
    s_sub_u32 s79, s79, 1
    s_cmp_lg_u32 s79, 0
    s_cbranch_scc1 LW_51
LD_52:
    s_add_u32 m0, s10, 0
    s_mov_b32 s12, 0
    s_waitcnt vmcnt(6)
    buffer_load_dwordx4 v242, s[52:55], s12 offen lds
    s_add_u32 m0, s10, 1024
    s_mov_b32 s12, 7168
    s_waitcnt vmcnt(6)
    buffer_load_dwordx4 v242, s[52:55], s12 offen lds
    s_add_u32 m0, s10, 2048
    s_mov_b32 s12, 14336
    s_waitcnt vmcnt(6)
    buffer_load_dwordx4 v242, s[52:55], s12 offen lds
    s_add_u32 m0, s10, 3072
    s_mov_b32 s12, 21504
    s_waitcnt vmcnt(6)
    buffer_load_dwordx4 v242, s[52:55], s12 offen lds
    s_add_u32 m0, s10, 4096
    s_mov_b32 s12, 28672
    s_waitcnt vmcnt(6)
    buffer_load_dwordx4 v242, s[52:55], s12 offen lds
    s_add_u32 m0, s10, 5120
    s_mov_b32 s12, 35840
    s_waitcnt vmcnt(6)
    buffer_load_dwordx4 v242, s[52:55], s12 offen lds
    s_add_u32 m0, s10, 6144
    s_mov_b32 s12, 43008
    s_waitcnt vmcnt(6)
    buffer_load_dwordx4 v242, s[52:55], s12 offen lds
    s_add_u32 m0, s10, 7168
    s_mov_b32 s12, 50176
    s_waitcnt vmcnt(6)
    buffer_load_dwordx4 v242, s[52:55], s12 offen lds
    s_waitcnt vmcnt(18)
    ds_read_b128 v[128:131], v8 offset:16384
    ds_read_b128 v[132:135], v8 offset:32768
    ds_read_b128 v[136:139], v9 offset:16384
    ds_read_b128 v[140:143], v9 offset:32768
    ds_read_b128 v[144:147], v10 offset:16384
    ds_read_b128 v[148:151], v10 offset:32768
    ds_read_b128 v[152:155], v11 offset:16384
    ds_read_b128 v[156:159], v11 offset:32768
    s_mov_b32 s79, 262144
    s_nop 0
F_EP:
    buffer_load_dwordx4 v[40:43], v248, s[60:63], 0 offen sc1
    s_waitcnt vmcnt(6)
    buffer_load_dwordx4 v[44:47], v249, s[60:63], 0 offen sc1
    s_waitcnt vmcnt(6)
    buffer_load_dwordx4 v[48:51], v250, s[60:63], 0 offen sc1
    s_waitcnt vmcnt(6)
    buffer_load_dwordx4 v[52:55], v251, s[60:63], 0 offen sc1
    s_waitcnt vmcnt(6)
    buffer_load_dwordx4 v[56:59], v252, s[60:63], 0 offen sc1
    s_waitcnt vmcnt(6)
    buffer_load_dwordx4 v[60:63], v253, s[60:63], 0 offen sc1
    s_waitcnt vmcnt(6)
    buffer_load_dwordx4 v[64:67], v254, s[60:63], 0 offen sc1
    s_waitcnt vmcnt(6)
    buffer_load_dwordx4 v[68:71], v255, s[60:63], 0 offen sc1
    s_waitcnt vmcnt(6)
    s_mov_b64 s[8:9], 0
    s_setprio 3
    s_waitcnt vmcnt(0)
    v_cmp_ne_u32 s[12:13], s77, v41
    v_cmp_ne_u32 vcc, s77, v43
    v_mov_b32 v41, v42
    s_or_b64 s[12:13], s[12:13], vcc
    s_and_b64 s[12:13], s[12:13], s[18:19]
    s_or_b64 s[8:9], s[8:9], s[12:13]
    v_cmp_ne_u32 s[12:13], s77, v45
    v_cmp_ne_u32 vcc, s77, v47
    v_mov_b32 v45, v46
    s_or_b64 s[12:13], s[12:13], vcc
    s_and_b64 s[12:13], s[12:13], s[20:21]
    s_or_b64 s[8:9], s[8:9], s[12:13]
    v_cmp_ne_u32 s[12:13], s77, v49
    v_cmp_ne_u32 vcc, s77, v51
    v_mov_b32 v49, v50
    s_or_b64 s[12:13], s[12:13], vcc
    s_and_b64 s[12:13], s[12:13], s[30:31]
    s_or_b64 s[8:9], s[8:9], s[12:13]
    v_cmp_ne_u32 s[12:13], s77, v53
    v_cmp_ne_u32 vcc, s77, v55
    v_mov_b32 v53, v54
    s_or_b64 s[12:13], s[12:13], vcc
    s_and_b64 s[12:13], s[12:13], s[34:35]
    s_or_b64 s[8:9], s[8:9], s[12:13]
    v_cmp_ne_u32 s[12:13], s77, v57
    v_cmp_ne_u32 vcc, s77, v59
    v_mov_b32 v57, v58
    s_or_b64 s[12:13], s[12:13], vcc
    s_and_b64 s[12:13], s[12:13], s[36:37]
    s_or_b64 s[8:9], s[8:9], s[12:13]
    v_cmp_ne_u32 s[12:13], s77, v61
    v_cmp_ne_u32 vcc, s77, v63
    v_mov_b32 v61, v62
    s_or_b64 s[12:13], s[12:13], vcc
    s_and_b64 s[12:13], s[12:13], s[38:39]
    s_or_b64 s[8:9], s[8:9], s[12:13]
    v_cmp_ne_u32 s[12:13], s77, v65
    v_cmp_ne_u32 vcc, s77, v67
    v_mov_b32 v65, v66
    s_or_b64 s[12:13], s[12:13], vcc
    s_and_b64 s[12:13], s[12:13], s[40:41]
    s_or_b64 s[8:9], s[8:9], s[12:13]
    v_cmp_ne_u32 s[12:13], s77, v69
    v_cmp_ne_u32 vcc, s77, v71
    v_mov_b32 v69, v70
    s_or_b64 s[12:13], s[12:13], vcc
    s_and_b64 s[12:13], s[12:13], s[46:47]
    s_or_b64 s[8:9], s[8:9], s[12:13]
    s_cbranch_scc0 F_EOK
    s_sleep 8
    s_sub_u32 s79, s79, 1
    s_cmp_lg_u32 s79, 0
    s_cbranch_scc1 F_EP
F_EOK:
    s_waitcnt lgkmcnt(0)
    ds_read_b128 v[160:163], v8 offset:49152
    ds_read_b128 v[164:167], v8 offset:0
    ds_read_b128 v[168:171], v9 offset:49152
    ds_read_b128 v[172:175], v9 offset:0
    ds_read_b128 v[176:179], v10 offset:49152
    ds_read_b128 v[180:183], v10 offset:0
    ds_read_b128 v[184:187], v11 offset:49152
    ds_read_b128 v[188:191], v11 offset:0
    s_add_u32 m0, s11, 16384
    s_add_u32 s12, s72, 256
    s_waitcnt vmcnt(6)
    buffer_load_dwordx4 v240, s[56:59], s12 offen lds
    s_add_u32 m0, s11, 17408
    s_add_u32 s12, s72, 256
    s_waitcnt vmcnt(6)
    buffer_load_dwordx4 v241, s[56:59], s12 offen lds
    s_add_u32 m0, s11, 18432
    s_add_u32 s12, s72, 14592
    s_waitcnt vmcnt(6)
    buffer_load_dwordx4 v240, s[56:59], s12 offen lds
    s_add_u32 m0, s11, 19456
    s_add_u32 s12, s72, 14592
    s_waitcnt vmcnt(6)
    buffer_load_dwordx4 v241, s[56:59], s12 offen lds
    v_pk_fma_f32 v[6:7], v[20:21], v[40:41], v[44:45] op_sel:[1,1,0] op_sel_hi:[1,0,1] neg_lo:[1,0,0]
    v_pk_fma_f32 v[28:29], v[20:21], v[40:41], v[6:7] op_sel_hi:[0,1,1]
    v_pk_fma_f32 v[6:7], v[20:21], v[28:29], v[48:49] op_sel:[1,1,0] op_sel_hi:[1,0,1] neg_lo:[1,0,0]
    v_pk_fma_f32 v[28:29], v[20:21], v[28:29], v[6:7] op_sel_hi:[0,1,1]
    v_pk_fma_f32 v[6:7], v[20:21], v[28:29], v[52:53] op_sel:[1,1,0] op_sel_hi:[1,0,1] neg_lo:[1,0,0]
    v_pk_fma_f32 v[28:29], v[20:21], v[28:29], v[6:7] op_sel_hi:[0,1,1]
    v_pk_fma_f32 v[6:7], v[20:21], v[28:29], v[56:57] op_sel:[1,1,0] op_sel_hi:[1,0,1] neg_lo:[1,0,0]
    v_pk_fma_f32 v[28:29], v[20:21], v[28:29], v[6:7] op_sel_hi:[0,1,1]
    v_pk_fma_f32 v[6:7], v[20:21], v[28:29], v[60:61] op_sel:[1,1,0] op_sel_hi:[1,0,1] neg_lo:[1,0,0]
    v_pk_fma_f32 v[28:29], v[20:21], v[28:29], v[6:7] op_sel_hi:[0,1,1]
    v_pk_fma_f32 v[6:7], v[20:21], v[28:29], v[64:65] op_sel:[1,1,0] op_sel_hi:[1,0,1] neg_lo:[1,0,0]
    v_pk_fma_f32 v[28:29], v[20:21], v[28:29], v[6:7] op_sel_hi:[0,1,1]
    v_pk_fma_f32 v[6:7], v[20:21], v[28:29], v[68:69] op_sel:[1,1,0] op_sel_hi:[1,0,1] neg_lo:[1,0,0]
    v_pk_fma_f32 v[28:29], v[20:21], v[28:29], v[6:7] op_sel_hi:[0,1,1]
    v_pk_mul_f32 v[6:7], v[22:23], v[28:29] op_sel:[1,1] op_sel_hi:[1,0] neg_lo:[1,0]
    v_pk_fma_f32 v[28:29], v[22:23], v[28:29], v[6:7] op_sel_hi:[0,1,1]
    v_mov_b32 v6, v28
    v_mov_b32 v7, v29
    s_nop 0
    v_permlane16_swap_b32 v28, v6
    v_permlane16_swap_b32 v29, v7
    v_pk_add_f32 v[28:29], v[28:29], v[6:7]
    v_mov_b32 v6, v28
    v_mov_b32 v7, v29
    s_nop 0
    v_permlane32_swap_b32 v28, v6
    v_permlane32_swap_b32 v29, v7
    v_pk_add_f32 v[28:29], v[28:29], v[6:7]
    v_nop
    v_nop
    s_lshl_b64 exec, -1, 16
    v_pk_fma_f32 v[6:7], v[18:19], v[28:29], v[104:105] op_sel:[1,1,0] op_sel_hi:[1,0,1] neg_lo:[1,0,0]
    v_pk_fma_f32 v[28:29], v[18:19], v[28:29], v[6:7] op_sel_hi:[0,1,1]
    v_nop
    v_nop
    s_lshl_b64 exec, -1, 32
    v_pk_fma_f32 v[6:7], v[18:19], v[28:29], v[106:107] op_sel:[1,1,0] op_sel_hi:[1,0,1] neg_lo:[1,0,0]
    v_pk_fma_f32 v[28:29], v[18:19], v[28:29], v[6:7] op_sel_hi:[0,1,1]
    v_nop
    v_nop
    s_lshl_b64 exec, -1, 48
    v_pk_fma_f32 v[6:7], v[18:19], v[28:29], v[108:109] op_sel:[1,1,0] op_sel_hi:[1,0,1] neg_lo:[1,0,0]
    v_pk_fma_f32 v[28:29], v[18:19], v[28:29], v[6:7] op_sel_hi:[0,1,1]
    v_nop
    v_nop
    s_mov_b64 exec, -1
    s_add_u32 m0, s11, 32768
    s_add_u32 s12, s73, 256
    s_waitcnt vmcnt(6)
    buffer_load_dwordx4 v240, s[56:59], s12 offen lds
    v_pk_fma_f32 v[6:7], v[16:17], v[28:29], v[72:73] op_sel:[1,1,0] op_sel_hi:[1,0,1] neg_lo:[1,0,0]
    v_pk_fma_f32 v[72:73], v[16:17], v[28:29], v[6:7] op_sel_hi:[0,1,1]
    v_pk_fma_f32 v[6:7], v[16:17], v[72:73], v[74:75] op_sel:[1,1,0] op_sel_hi:[1,0,1] neg_lo:[1,0,0]
    v_pk_fma_f32 v[74:75], v[16:17], v[72:73], v[6:7] op_sel_hi:[0,1,1]
    v_pk_fma_f32 v[6:7], v[16:17], v[74:75], v[76:77] op_sel:[1,1,0] op_sel_hi:[1,0,1] neg_lo:[1,0,0]
    v_pk_fma_f32 v[76:77], v[16:17], v[74:75], v[6:7] op_sel_hi:[0,1,1]
    v_cvt_pk_bf16_f32 v40, v72, v74
    v_cvt_pk_bf16_f32 v48, v73, v75
    v_pk_fma_f32 v[6:7], v[16:17], v[76:77], v[78:79] op_sel:[1,1,0] op_sel_hi:[1,0,1] neg_lo:[1,0,0]
    v_pk_fma_f32 v[78:79], v[16:17], v[76:77], v[6:7] op_sel_hi:[0,1,1]
    s_add_u32 m0, s11, 33792
    s_add_u32 s12, s73, 256
    s_waitcnt vmcnt(6)
    buffer_load_dwordx4 v241, s[56:59], s12 offen lds
    v_pk_fma_f32 v[6:7], v[16:17], v[78:79], v[80:81] op_sel:[1,1,0] op_sel_hi:[1,0,1] neg_lo:[1,0,0]
    v_pk_fma_f32 v[80:81], v[16:17], v[78:79], v[6:7] op_sel_hi:[0,1,1]
    v_cvt_pk_bf16_f32 v41, v76, v78
    v_cvt_pk_bf16_f32 v49, v77, v79
    v_pk_fma_f32 v[6:7], v[16:17], v[80:81], v[82:83] op_sel:[1,1,0] op_sel_hi:[1,0,1] neg_lo:[1,0,0]
    v_pk_fma_f32 v[82:83], v[16:17], v[80:81], v[6:7] op_sel_hi:[0,1,1]
    v_pk_fma_f32 v[6:7], v[16:17], v[82:83], v[84:85] op_sel:[1,1,0] op_sel_hi:[1,0,1] neg_lo:[1,0,0]
    v_pk_fma_f32 v[84:85], v[16:17], v[82:83], v[6:7] op_sel_hi:[0,1,1]
    v_cvt_pk_bf16_f32 v42, v80, v82
    v_cvt_pk_bf16_f32 v50, v81, v83
    v_pk_fma_f32 v[6:7], v[16:17], v[84:85], v[86:87] op_sel:[1,1,0] op_sel_hi:[1,0,1] neg_lo:[1,0,0]
    v_pk_fma_f32 v[86:87], v[16:17], v[84:85], v[6:7] op_sel_hi:[0,1,1]
    s_add_u32 m0, s11, 34816
    s_add_u32 s12, s73, 14592
    s_waitcnt vmcnt(6)
    buffer_load_dwordx4 v240, s[56:59], s12 offen lds
    v_pk_fma_f32 v[6:7], v[16:17], v[86:87], v[88:89] op_sel:[1,1,0] op_sel_hi:[1,0,1] neg_lo:[1,0,0]
    v_pk_fma_f32 v[88:89], v[16:17], v[86:87], v[6:7] op_sel_hi:[0,1,1]
    v_cvt_pk_bf16_f32 v43, v84, v86
    v_cvt_pk_bf16_f32 v51, v85, v87
    v_pk_fma_f32 v[6:7], v[16:17], v[88:89], v[90:91] op_sel:[1,1,0] op_sel_hi:[1,0,1] neg_lo:[1,0,0]
    v_pk_fma_f32 v[90:91], v[16:17], v[88:89], v[6:7] op_sel_hi:[0,1,1]
    v_pk_fma_f32 v[6:7], v[16:17], v[90:91], v[92:93] op_sel:[1,1,0] op_sel_hi:[1,0,1] neg_lo:[1,0,0]
    v_pk_fma_f32 v[92:93], v[16:17], v[90:91], v[6:7] op_sel_hi:[0,1,1]
    v_cvt_pk_bf16_f32 v44, v88, v90
    v_cvt_pk_bf16_f32 v52, v89, v91
    v_pk_fma_f32 v[6:7], v[16:17], v[92:93], v[94:95] op_sel:[1,1,0] op_sel_hi:[1,0,1] neg_lo:[1,0,0]
    v_pk_fma_f32 v[94:95], v[16:17], v[92:93], v[6:7] op_sel_hi:[0,1,1]
    s_add_u32 m0, s11, 35840
    s_add_u32 s12, s73, 14592
    s_waitcnt vmcnt(6)
    buffer_load_dwordx4 v241, s[56:59], s12 offen lds
    v_pk_fma_f32 v[6:7], v[16:17], v[94:95], v[96:97] op_sel:[1,1,0] op_sel_hi:[1,0,1] neg_lo:[1,0,0]
    v_pk_fma_f32 v[96:97], v[16:17], v[94:95], v[6:7] op_sel_hi:[0,1,1]
    v_cvt_pk_bf16_f32 v45, v92, v94
    v_cvt_pk_bf16_f32 v53, v93, v95
    v_pk_fma_f32 v[6:7], v[16:17], v[96:97], v[98:99] op_sel:[1,1,0] op_sel_hi:[1,0,1] neg_lo:[1,0,0]
    v_pk_fma_f32 v[98:99], v[16:17], v[96:97], v[6:7] op_sel_hi:[0,1,1]
    v_pk_fma_f32 v[6:7], v[16:17], v[98:99], v[100:101] op_sel:[1,1,0] op_sel_hi:[1,0,1] neg_lo:[1,0,0]
    v_pk_fma_f32 v[100:101], v[16:17], v[98:99], v[6:7] op_sel_hi:[0,1,1]
    v_cvt_pk_bf16_f32 v46, v96, v98
    v_cvt_pk_bf16_f32 v54, v97, v99
    v_pk_fma_f32 v[6:7], v[16:17], v[100:101], v[102:103] op_sel:[1,1,0] op_sel_hi:[1,0,1] neg_lo:[1,0,0]
    v_pk_fma_f32 v[102:103], v[16:17], v[100:101], v[6:7] op_sel_hi:[0,1,1]
    v_cvt_pk_bf16_f32 v47, v100, v102
    v_cvt_pk_bf16_f32 v55, v101, v103
    ds_write_b128 v243, v[40:43]
    ds_write_b128 v243, v[44:47] offset:16
    ds_write_b128 v243, v[48:51] offset:2304
    ds_write_b128 v243, v[52:55] offset:2320
    ds_read_b64_tr_b16 v[56:57], v244 offset:0
    ds_read_b64_tr_b16 v[58:59], v244 offset:576
    ds_read_b64_tr_b16 v[60:61], v244 offset:32
    ds_read_b64_tr_b16 v[62:63], v244 offset:608
    ds_read_b64_tr_b16 v[64:65], v244 offset:2304
    ds_read_b64_tr_b16 v[66:67], v244 offset:2880
    ds_read_b64_tr_b16 v[68:69], v244 offset:2336
    ds_read_b64_tr_b16 v[70:71], v244 offset:2912
    s_add_u32 s60, s48, 10485760
    s_addc_u32 s61, s49, 0
    s_mov_b32 s62, 3670016
    s_mov_b32 s63, 0x00020000
    s_lshl_b32 s8, s51, 2
    s_add_u32 s8, s8, s5
    s_mul_i32 s9, s50, 56
    s_add_u32 s9, s9, s8
    s_lshl_b32 s9, s9, 11
    s_add_u32 s12, s9, 57344
    s_mul_i32 s13, s50, 28
    s_add_u32 s13, s13, s8
    s_lshl_b32 s13, s13, 6
    s_add_u32 s13, s13, 81920
    v_mov_b32 v6, 0
    s_waitcnt lgkmcnt(0)
    buffer_store_dwordx4 v[56:59], v4, s[60:63], s9 offen offset:0 sc1
    buffer_store_dwordx4 v[60:63], v4, s[60:63], s9 offen offset:1024 sc1
    buffer_store_dwordx4 v[64:67], v4, s[60:63], s12 offen offset:0 sc1
    buffer_store_dwordx4 v[68:71], v4, s[60:63], s12 offen offset:1024 sc1
    s_waitcnt vmcnt(0)
    s_mov_b64 exec, 1
    buffer_store_dword v115, v6, s[64:67], s13 offen sc1
    s_mov_b64 exec, -1
    s_setprio 1
    ds_read_b128 v[192:195], v8 offset:16384
    ds_read_b128 v[196:199], v8 offset:32768
    ds_read_b128 v[200:203], v9 offset:16384
    ds_read_b128 v[204:207], v9 offset:32768
    ds_read_b128 v[208:211], v10 offset:16384
    ds_read_b128 v[212:215], v10 offset:32768
    ds_read_b128 v[216:219], v11 offset:16384
    ds_read_b128 v[220:223], v11 offset:32768
    s_add_u32 m0, s11, 49152
    s_add_u32 s12, s74, 384
    s_waitcnt vmcnt(6)
    buffer_load_dwordx4 v12, s[56:59], s12 offen lds
    s_add_u32 m0, s11, 50176
    s_add_u32 s12, s74, 384
    s_waitcnt vmcnt(6)
    buffer_load_dwordx4 v13, s[56:59], s12 offen lds
    s_add_u32 m0, s11, 51200
    s_add_u32 s12, s74, 14720
    s_waitcnt vmcnt(6)
    buffer_load_dwordx4 v12, s[56:59], s12 offen lds
    s_add_u32 m0, s11, 52224
    s_add_u32 s12, s74, 14720
    s_waitcnt vmcnt(6)
    buffer_load_dwordx4 v13, s[56:59], s12 offen lds
    s_add_u32 m0, s11, 0
    s_add_u32 s12, s75, 384
    s_waitcnt vmcnt(6)
    buffer_load_dwordx4 v12, s[56:59], s12 offen lds
    s_add_u32 m0, s11, 1024
    s_add_u32 s12, s75, 384
    s_waitcnt vmcnt(6)
    buffer_load_dwordx4 v13, s[56:59], s12 offen lds
    s_add_u32 m0, s11, 2048
    s_add_u32 s12, s75, 14720
    s_waitcnt vmcnt(6)
    buffer_load_dwordx4 v12, s[56:59], s12 offen lds
    s_add_u32 m0, s11, 3072
    s_add_u32 s12, s75, 14720
    s_waitcnt vmcnt(6)
    buffer_load_dwordx4 v13, s[56:59], s12 offen lds
    s_add_u32 m0, s10, 8192
    s_mov_b32 s12, 57344
    s_waitcnt vmcnt(6)
    buffer_load_dwordx4 v242, s[52:55], s12 offen lds
    s_add_u32 m0, s10, 9216
    s_mov_b32 s12, 64512
    s_waitcnt vmcnt(6)
    buffer_load_dwordx4 v242, s[52:55], s12 offen lds
    s_add_u32 m0, s10, 10240
    s_mov_b32 s12, 71680
    s_waitcnt vmcnt(6)
    buffer_load_dwordx4 v242, s[52:55], s12 offen lds
    s_add_u32 m0, s10, 11264
    s_mov_b32 s12, 78848
    s_waitcnt vmcnt(6)
    buffer_load_dwordx4 v242, s[52:55], s12 offen lds
    s_add_u32 m0, s10, 12288
    s_mov_b32 s12, 86016
    s_waitcnt vmcnt(6)
    buffer_load_dwordx4 v242, s[52:55], s12 offen lds
    s_add_u32 m0, s10, 13312
    s_mov_b32 s12, 93184
    s_waitcnt vmcnt(6)
    buffer_load_dwordx4 v242, s[52:55], s12 offen lds
    s_add_u32 m0, s10, 14336
    s_mov_b32 s12, 100352
    s_waitcnt vmcnt(6)
    buffer_load_dwordx4 v242, s[52:55], s12 offen lds
    s_waitcnt vmcnt(7)
    ds_read_b128 v[224:227], v8 offset:49152
    ds_read_b128 v[228:231], v8 offset:0
    ds_read_b128 v[232:235], v9 offset:49152
    ds_read_b128 v[236:239], v9 offset:0
    s_waitcnt lgkmcnt(0)
    s_mov_b64 exec, 1
    ds_add_u32 v14, v15 offset:68
    s_mov_b64 exec, -1
    s_mul_i32 s8, s14, 14
    s_mul_i32 s13, s50, 28
    s_add_u32 s13, s13, s8
    s_lshl_b32 s13, s13, 6
    s_add_u32 s13, s13, 81920
    s_lshl_b32 s12, s50, 1
    s_add_u32 s12, s12, s15
    s_mul_i32 s12, s12, 28
    s_add_u32 s72, s12, s8
    s_lshl_b32 s72, s72, 11
    s_lshl_b32 s73, s51, 5
    v_and_b32 v6, 31, v1
    v_add_lshl_u32 v6, v6, s73, 7
    s_lshl_b32 s9, s14, 1
    s_add_u32 s9, s9, s12
    s_add_u32 s9, s9, 12
    s_lshl_b32 s9, s9, 11
    s_lshl_b32 s8, s14, 4
    s_add_u32 s12, s12, s8
    s_lshl_b32 s12, s12, 11
    s_mov_b32 s56, s44
    s_mov_b32 s57, s45
    s_mov_b32 s58, 7340032
    s_mov_b32 s59, 0x00020000
    v_lshlrev_b32 v40, 16, v116
    v_and_b32 v41, 0xffff0000, v116
    v_lshlrev_b32 v42, 16, v117
    v_and_b32 v43, 0xffff0000, v117
    v_lshlrev_b32 v44, 16, v118
    v_and_b32 v45, 0xffff0000, v118
    v_lshlrev_b32 v46, 16, v119
    v_and_b32 v47, 0xffff0000, v119
    v_lshlrev_b32 v48, 16, v245
    v_and_b32 v49, 0xffff0000, v245
    v_lshlrev_b32 v50, 16, v246
    v_and_b32 v51, 0xffff0000, v246
    v_lshlrev_b32 v52, 16, v247
    v_and_b32 v53, 0xffff0000, v247
    v_lshlrev_b32 v54, 16, v31
    v_and_b32 v55, 0xffff0000, v31
    v_pk_mul_f32 v[40:41], v[124:125], v[40:41] op_sel:[1,0] op_sel_hi:[1,1]
    v_pk_mul_f32 v[42:43], v[124:125], v[42:43] op_sel:[1,0] op_sel_hi:[1,1]
    v_pk_mul_f32 v[44:45], v[124:125], v[44:45] op_sel:[1,0] op_sel_hi:[1,1]
    v_pk_mul_f32 v[46:47], v[124:125], v[46:47] op_sel:[1,0] op_sel_hi:[1,1]
    v_pk_mul_f32 v[48:49], v[124:125], v[48:49] op_sel:[1,0] op_sel_hi:[1,1]
    v_pk_mul_f32 v[50:51], v[124:125], v[50:51] op_sel:[1,0] op_sel_hi:[1,1]
    v_pk_mul_f32 v[52:53], v[124:125], v[52:53] op_sel:[1,0] op_sel_hi:[1,1]
    v_pk_mul_f32 v[54:55], v[124:125], v[54:55] op_sel:[1,0] op_sel_hi:[1,1]
    s_waitcnt vmcnt(0)
    v_nop
    v_nop
    s_mov_b64 exec, 1
    ds_add_u32 v14, v15 offset:20
    s_mov_b64 exec, -1
    s_mov_b32 s79, 262144
PW_53:
    buffer_load_dword v5, v124, s[64:67], s13 offen sc1
    s_waitcnt vmcnt(0)
    v_cmp_ne_u32 vcc, s77, v5
    s_nop 0
    s_cbranch_vccz PD_54
    s_sleep 4
    s_sub_u32 s79, s79, 1
    s_cmp_lg_u32 s79, 0
    s_cbranch_scc1 PW_53
PD_54:
    buffer_load_dwordx4 v[16:19], v120, s[60:63], s12 offen offset:0 sc1
    buffer_load_dwordx4 v[20:23], v121, s[60:63], s12 offen offset:0 sc1
    s_waitcnt vmcnt(4)
    buffer_load_dwordx4 v[24:27], v120, s[60:63], s12 offen offset:2048 sc1
    buffer_load_dwordx4 v[28:31], v121, s[60:63], s12 offen offset:2048 sc1
    s_add_u32 s12, s12, 4096
    s_waitcnt vmcnt(4)
    buffer_load_dwordx4 v[32:35], v120, s[60:63], s12 offen offset:0 sc1
    buffer_load_dwordx4 v[36:39], v121, s[60:63], s12 offen offset:0 sc1
    s_waitcnt vmcnt(4)
    buffer_load_dwordx4 v[104:107], v120, s[60:63], s12 offen offset:2048 sc1
    buffer_load_dwordx4 v[108:111], v121, s[60:63], s12 offen offset:2048 sc1
    s_add_u32 s12, s12, 4096
    s_waitcnt vmcnt(4)
    buffer_load_dwordx4 v[112:115], v120, s[60:63], s12 offen offset:0 sc1
    buffer_load_dwordx4 v[116:119], v121, s[60:63], s12 offen offset:0 sc1
    s_waitcnt vmcnt(4)
    buffer_load_dwordx4 v[240:243], v120, s[60:63], s12 offen offset:2048 sc1
    buffer_load_dwordx4 v[244:247], v121, s[60:63], s12 offen offset:2048 sc1
    s_add_u32 s12, s12, 4096
    s_waitcnt vmcnt(4)
    buffer_load_dwordx4 v[248:251], v120, s[60:63], s12 offen offset:0 sc1
    buffer_load_dwordx4 v[252:255], v121, s[60:63], s12 offen offset:0 sc1
    s_waitcnt vmcnt(4)
    s_mul_i32 s10, s5, 12288
    s_add_u32 s10, s10, 49152
    v_add_u32 v13, s10, v4
    s_mov_b32 s79, 262144
LW_55:
    ds_read_b32 v5, v14 offset:68
    s_waitcnt lgkmcnt(0)
    v_readfirstlane_b32 s78, v5
    s_nop 0
    s_cmp_ge_u32 s78, 4
    s_cbranch_scc1 LD_56
    s_sleep 1
    s_sub_u32 s79, s79, 1
    s_cmp_lg_u32 s79, 0
    s_cbranch_scc1 LW_55
LD_56:
    s_add_u32 m0, s10, 2048
    s_sub_u32 m0, m0, 4096
    s_nop 0
    buffer_load_dwordx4 v120, s[60:63], s12 offen offset:2048 sc1 lds
    s_add_u32 m0, m0, 1024
    s_waitcnt vmcnt(4)
    buffer_load_dwordx4 v121, s[60:63], s12 offen offset:2048 sc1 lds
    s_add_u32 s12, s12, 4096
    s_add_u32 m0, s10, 6144
    s_sub_u32 m0, m0, 4096
    s_nop 0
    buffer_load_dwordx4 v120, s[60:63], s12 offen offset:0 sc1 lds
    s_add_u32 m0, m0, 1024
    s_waitcnt vmcnt(4)
    buffer_load_dwordx4 v121, s[60:63], s12 offen offset:0 sc1 lds
    s_add_u32 m0, s10, 6144
    s_sub_u32 m0, m0, 4096
    s_nop 0
    buffer_load_dwordx4 v120, s[60:63], s12 offen offset:2048 sc1 lds
    s_add_u32 m0, m0, 1024
    s_waitcnt vmcnt(4)
    buffer_load_dwordx4 v121, s[60:63], s12 offen offset:2048 sc1 lds
    s_add_u32 s12, s12, 4096
    s_add_u32 m0, s10, 10240
    s_sub_u32 m0, m0, 4096
    s_nop 0
    buffer_load_dwordx4 v120, s[60:63], s12 offen offset:0 sc1 lds
    s_add_u32 m0, m0, 1024
    s_waitcnt vmcnt(4)
    buffer_load_dwordx4 v121, s[60:63], s12 offen offset:0 sc1 lds
    s_add_u32 m0, s10, 10240
    s_sub_u32 m0, m0, 4096
    s_nop 0
    buffer_load_dwordx4 v120, s[60:63], s12 offen offset:2048 sc1 lds
    s_add_u32 m0, m0, 1024
    s_waitcnt vmcnt(4)
    buffer_load_dwordx4 v121, s[60:63], s12 offen offset:2048 sc1 lds
    s_mov_b32 s12, s9
    s_add_u32 m0, s10, 14336
    s_sub_u32 m0, m0, 4096
    s_nop 0
    buffer_load_dwordx4 v120, s[60:63], s12 offen offset:0 sc1 lds
    s_add_u32 m0, m0, 1024
    s_waitcnt vmcnt(4)
    buffer_load_dwordx4 v121, s[60:63], s12 offen offset:0 sc1 lds
    s_setprio 0
    s_mov_b32 s79, 262144
LW_57:
    ds_read_b32 v5, v14 offset:24
    s_waitcnt lgkmcnt(0)
    v_readfirstlane_b32 s78, v5
    s_nop 0
    s_cmp_ge_u32 s78, 4
    s_cbranch_scc1 LD_58
    s_sleep 2
    s_sub_u32 s79, s79, 1
    s_cmp_lg_u32 s79, 0
    s_cbranch_scc1 LW_57
LD_58:
    s_waitcnt vmcnt(24)
    v_mfma_f32_32x32x16_bf16 v[40:55], v[16:19], v[128:131], v[40:55]
    v_mfma_f32_32x32x16_bf16 v[56:71], v[16:19], v[132:135], 0
    v_mfma_f32_32x32x16_bf16 v[72:87], v[20:23], v[128:131], 0
    v_mfma_f32_32x32x16_bf16 v[88:103], v[20:23], v[132:135], 0
    buffer_load_dwordx4 v[16:19], v120, s[60:63], s12 offen offset:2048 sc1
    buffer_load_dwordx4 v[20:23], v121, s[60:63], s12 offen offset:2048 sc1
    s_waitcnt vmcnt(24)
    v_mfma_f32_32x32x16_bf16 v[40:55], v[24:27], v[136:139], v[40:55]
    v_mfma_f32_32x32x16_bf16 v[56:71], v[24:27], v[140:143], v[56:71]
    v_mfma_f32_32x32x16_bf16 v[72:87], v[28:31], v[136:139], v[72:87]
    v_mfma_f32_32x32x16_bf16 v[88:103], v[28:31], v[140:143], v[88:103]
    s_waitcnt vmcnt(2)
    ds_read_b128 v[24:27], v13 offset:0
    ds_read_b128 v[28:31], v13 offset:1024
    s_waitcnt vmcnt(22)
    v_mfma_f32_32x32x16_bf16 v[40:55], v[32:35], v[144:147], v[40:55]
    v_mfma_f32_32x32x16_bf16 v[56:71], v[32:35], v[148:151], v[56:71]
    v_mfma_f32_32x32x16_bf16 v[72:87], v[36:39], v[144:147], v[72:87]
    v_mfma_f32_32x32x16_bf16 v[88:103], v[36:39], v[148:151], v[88:103]
    ds_read_b128 v[32:35], v13 offset:2048
    ds_read_b128 v[36:39], v13 offset:3072
    s_waitcnt vmcnt(20)
    v_mfma_f32_32x32x16_bf16 v[40:55], v[104:107], v[152:155], v[40:55]
    v_mfma_f32_32x32x16_bf16 v[56:71], v[104:107], v[156:159], v[56:71]
    v_mfma_f32_32x32x16_bf16 v[72:87], v[108:111], v[152:155], v[72:87]
    v_mfma_f32_32x32x16_bf16 v[88:103], v[108:111], v[156:159], v[88:103]
    ds_read_b128 v[104:107], v13 offset:4096
    ds_read_b128 v[108:111], v13 offset:5120
    s_waitcnt vmcnt(18)
    v_mfma_f32_32x32x16_bf16 v[40:55], v[112:115], v[160:163], v[40:55]
    v_mfma_f32_32x32x16_bf16 v[56:71], v[112:115], v[164:167], v[56:71]
    v_mfma_f32_32x32x16_bf16 v[72:87], v[116:119], v[160:163], v[72:87]
    v_mfma_f32_32x32x16_bf16 v[88:103], v[116:119], v[164:167], v[88:103]
    ds_read_b128 v[112:115], v13 offset:6144
    ds_read_b128 v[116:119], v13 offset:7168
    s_waitcnt vmcnt(16)
    v_mfma_f32_32x32x16_bf16 v[40:55], v[240:243], v[168:171], v[40:55]
    v_mfma_f32_32x32x16_bf16 v[56:71], v[240:243], v[172:175], v[56:71]
    v_mfma_f32_32x32x16_bf16 v[72:87], v[244:247], v[168:171], v[72:87]
    v_mfma_f32_32x32x16_bf16 v[88:103], v[244:247], v[172:175], v[88:103]
    ds_read_b128 v[240:243], v13 offset:8192
    ds_read_b128 v[244:247], v13 offset:9216
    s_waitcnt vmcnt(14)
    v_mfma_f32_32x32x16_bf16 v[40:55], v[248:251], v[176:179], v[40:55]
    v_mfma_f32_32x32x16_bf16 v[56:71], v[248:251], v[180:183], v[56:71]
    v_mfma_f32_32x32x16_bf16 v[72:87], v[252:255], v[176:179], v[72:87]
    v_mfma_f32_32x32x16_bf16 v[88:103], v[252:255], v[180:183], v[88:103]
    ds_read_b128 v[248:251], v13 offset:10240
    ds_read_b128 v[252:255], v13 offset:11264
    s_waitcnt lgkmcnt(10)
    v_mfma_f32_32x32x16_bf16 v[40:55], v[24:27], v[184:187], v[40:55]
    v_mfma_f32_32x32x16_bf16 v[56:71], v[24:27], v[188:191], v[56:71]
    v_mfma_f32_32x32x16_bf16 v[72:87], v[28:31], v[184:187], v[72:87]
    v_mfma_f32_32x32x16_bf16 v[88:103], v[28:31], v[188:191], v[88:103]
    s_waitcnt lgkmcnt(8)
    v_mfma_f32_32x32x16_bf16 v[40:55], v[32:35], v[192:195], v[40:55]
    v_mfma_f32_32x32x16_bf16 v[56:71], v[32:35], v[196:199], v[56:71]
    v_mfma_f32_32x32x16_bf16 v[72:87], v[36:39], v[192:195], v[72:87]
    v_mfma_f32_32x32x16_bf16 v[88:103], v[36:39], v[196:199], v[88:103]
    s_waitcnt lgkmcnt(6)
    v_mfma_f32_32x32x16_bf16 v[40:55], v[104:107], v[200:203], v[40:55]
    v_mfma_f32_32x32x16_bf16 v[56:71], v[104:107], v[204:207], v[56:71]
    v_mfma_f32_32x32x16_bf16 v[72:87], v[108:111], v[200:203], v[72:87]
    v_mfma_f32_32x32x16_bf16 v[88:103], v[108:111], v[204:207], v[88:103]
    s_waitcnt lgkmcnt(4)
    v_mfma_f32_32x32x16_bf16 v[40:55], v[112:115], v[208:211], v[40:55]
    v_mfma_f32_32x32x16_bf16 v[56:71], v[112:115], v[212:215], v[56:71]
    v_mfma_f32_32x32x16_bf16 v[72:87], v[116:119], v[208:211], v[72:87]
    v_mfma_f32_32x32x16_bf16 v[88:103], v[116:119], v[212:215], v[88:103]
    s_waitcnt lgkmcnt(2)
    v_mfma_f32_32x32x16_bf16 v[40:55], v[240:243], v[216:219], v[40:55]
    v_mfma_f32_32x32x16_bf16 v[56:71], v[240:243], v[220:223], v[56:71]
    v_mfma_f32_32x32x16_bf16 v[72:87], v[244:247], v[216:219], v[72:87]
    v_mfma_f32_32x32x16_bf16 v[88:103], v[244:247], v[220:223], v[88:103]
    s_waitcnt lgkmcnt(0)
    v_mfma_f32_32x32x16_bf16 v[40:55], v[248:251], v[224:227], v[40:55]
    v_mfma_f32_32x32x16_bf16 v[56:71], v[248:251], v[228:231], v[56:71]
    v_mfma_f32_32x32x16_bf16 v[72:87], v[252:255], v[224:227], v[72:87]
    v_mfma_f32_32x32x16_bf16 v[88:103], v[252:255], v[228:231], v[88:103]
    v_nop
    v_nop
    s_mov_b64 exec, 1
    ds_add_u32 v14, v15 offset:68
    s_mov_b64 exec, -1
    s_waitcnt vmcnt(0)
    v_mfma_f32_32x32x16_bf16 v[40:55], v[16:19], v[232:235], v[40:55]
    v_mfma_f32_32x32x16_bf16 v[56:71], v[16:19], v[236:239], v[56:71]
    v_mfma_f32_32x32x16_bf16 v[72:87], v[20:23], v[232:235], v[72:87]
    v_mfma_f32_32x32x16_bf16 v[88:103], v[20:23], v[236:239], v[88:103]
    s_setprio 2
    s_mov_b32 s79, 262144
LW_59:
    ds_read_b32 v5, v14 offset:68
    s_waitcnt lgkmcnt(0)
    v_readfirstlane_b32 s78, v5
    s_nop 0
    s_cmp_ge_u32 s78, 8
    s_cbranch_scc1 LD_60
    s_sleep 1
    s_sub_u32 s79, s79, 1
    s_cmp_lg_u32 s79, 0
    s_cbranch_scc1 LW_59
LD_60:
    s_xor_b32 s8, s5, 1
    s_mul_i32 s8, s8, 12288
    s_add_u32 s8, s8, 49152
    v_add_u32 v5, s8, v4
    ds_write_b128 v5, v[56:59] offset:0
    ds_write_b128 v5, v[60:63] offset:1024
    ds_write_b128 v5, v[64:67] offset:2048
    ds_write_b128 v5, v[68:71] offset:3072
    s_xor_b32 s8, s5, 2
    s_mul_i32 s8, s8, 12288
    s_add_u32 s8, s8, 49152
    v_add_u32 v5, s8, v4
    ds_write_b128 v5, v[72:75] offset:4096
    ds_write_b128 v5, v[76:79] offset:5120
    ds_write_b128 v5, v[80:83] offset:6144
    ds_write_b128 v5, v[84:87] offset:7168
    s_xor_b32 s8, s5, 3
    s_mul_i32 s8, s8, 12288
    s_add_u32 s8, s8, 49152
    v_add_u32 v5, s8, v4
    ds_write_b128 v5, v[88:91] offset:8192
    ds_write_b128 v5, v[92:95] offset:9216
    ds_write_b128 v5, v[96:99] offset:10240
    ds_write_b128 v5, v[100:103] offset:11264
    s_waitcnt lgkmcnt(0)
    s_mov_b64 exec, 1
    ds_add_u32 v14, v15 offset:68
    s_mov_b64 exec, -1
    s_mov_b32 s79, 262144
LW_61:
    ds_read_b32 v5, v14 offset:68
    s_waitcnt lgkmcnt(0)
    v_readfirstlane_b32 s78, v5
    s_nop 0
    s_cmp_ge_u32 s78, 12
    s_cbranch_scc1 LD_62
    s_sleep 1
    s_sub_u32 s79, s79, 1
    s_cmp_lg_u32 s79, 0
    s_cbranch_scc1 LW_61
LD_62:
    ds_read_b128 v[56:59], v13 offset:0
    ds_read_b128 v[72:75], v13 offset:4096
    ds_read_b128 v[88:91], v13 offset:8192
    ds_read_b128 v[60:63], v13 offset:1024
    ds_read_b128 v[76:79], v13 offset:5120
    ds_read_b128 v[92:95], v13 offset:9216
    ds_read_b128 v[64:67], v13 offset:2048
    ds_read_b128 v[80:83], v13 offset:6144
    ds_read_b128 v[96:99], v13 offset:10240
    ds_read_b128 v[68:71], v13 offset:3072
    ds_read_b128 v[84:87], v13 offset:7168
    ds_read_b128 v[100:103], v13 offset:11264
    s_mov_b32 s8, 0
    s_waitcnt lgkmcnt(9)
    v_add_f32 v40, v40, v56
    v_add_f32 v41, v41, v57
    v_add_f32 v42, v42, v58
    v_add_f32 v43, v43, v59
    v_add_f32 v40, v40, v72
    v_add_f32 v41, v41, v73
    v_add_f32 v42, v42, v74
    v_add_f32 v43, v43, v75
    v_add_f32 v40, v40, v88
    v_add_f32 v41, v41, v89
    v_add_f32 v42, v42, v90
    v_add_f32 v43, v43, v91
    buffer_store_dword v40, v122, s[56:59], s8 offen offset:0 sc1
    buffer_store_dword v41, v122, s[56:59], s8 offen offset:3584 sc1
    s_add_u32 s8, s8, 7168
    buffer_store_dword v42, v122, s[56:59], s8 offen offset:0 sc1
    buffer_store_dword v43, v122, s[56:59], s8 offen offset:3584 sc1
    s_add_u32 s8, s8, 7168
    s_waitcnt lgkmcnt(6)
    v_add_f32 v44, v44, v60
    v_add_f32 v45, v45, v61
    v_add_f32 v46, v46, v62
    v_add_f32 v47, v47, v63
    v_add_f32 v44, v44, v76
    v_add_f32 v45, v45, v77
    v_add_f32 v46, v46, v78
    v_add_f32 v47, v47, v79
    v_add_f32 v44, v44, v92
    v_add_f32 v45, v45, v93
    v_add_f32 v46, v46, v94
    v_add_f32 v47, v47, v95
    buffer_store_dword v44, v122, s[56:59], s8 offen offset:0 sc1
    buffer_store_dword v45, v122, s[56:59], s8 offen offset:3584 sc1
    s_add_u32 s8, s8, 7168
    buffer_store_dword v46, v122, s[56:59], s8 offen offset:0 sc1
    buffer_store_dword v47, v122, s[56:59], s8 offen offset:3584 sc1
    s_add_u32 s8, s8, 7168
    s_waitcnt lgkmcnt(3)
    v_add_f32 v48, v48, v64
    v_add_f32 v49, v49, v65
    v_add_f32 v50, v50, v66
    v_add_f32 v51, v51, v67
    v_add_f32 v48, v48, v80
    v_add_f32 v49, v49, v81
    v_add_f32 v50, v50, v82
    v_add_f32 v51, v51, v83
    v_add_f32 v48, v48, v96
    v_add_f32 v49, v49, v97
    v_add_f32 v50, v50, v98
    v_add_f32 v51, v51, v99
    buffer_store_dword v48, v122, s[56:59], s8 offen offset:0 sc1
    buffer_store_dword v49, v122, s[56:59], s8 offen offset:3584 sc1
    s_add_u32 s8, s8, 7168
    buffer_store_dword v50, v122, s[56:59], s8 offen offset:0 sc1
    buffer_store_dword v51, v122, s[56:59], s8 offen offset:3584 sc1
    s_add_u32 s8, s8, 7168
    s_waitcnt lgkmcnt(0)
    v_add_f32 v52, v52, v68
    v_add_f32 v53, v53, v69
    v_add_f32 v54, v54, v70
    v_add_f32 v55, v55, v71
    v_add_f32 v52, v52, v84
    v_add_f32 v53, v53, v85
    v_add_f32 v54, v54, v86
    v_add_f32 v55, v55, v87
    v_add_f32 v52, v52, v100
    v_add_f32 v53, v53, v101
    v_add_f32 v54, v54, v102
    v_add_f32 v55, v55, v103
    buffer_store_dword v52, v122, s[56:59], s8 offen offset:0 sc1
    buffer_store_dword v53, v122, s[56:59], s8 offen offset:3584 sc1
    s_add_u32 s8, s8, 7168
    buffer_store_dword v54, v122, s[56:59], s8 offen offset:0 sc1
    buffer_store_dword v55, v122, s[56:59], s8 offen offset:3584 sc1
    s_add_u32 s8, s8, 7168
    s_endpgm
F_A7:
    s_mov_b32 s79, 262144
LW_63:
    ds_read_b32 v5, v14 offset:28
    s_waitcnt lgkmcnt(0)
    v_readfirstlane_b32 s77, v5
    s_nop 0
    s_cmp_lg_u32 s77, 0
    s_cbranch_scc1 LD_64
    s_sleep 2
    s_sub_u32 s79, s79, 1
    s_cmp_lg_u32 s79, 0
    s_cbranch_scc1 LW_63
LD_64:
    s_setprio 1
    s_mov_b32 s79, 262144
LW_65:
    ds_read_b32 v5, v14 offset:20
    s_waitcnt lgkmcnt(0)
    v_readfirstlane_b32 s78, v5
    s_nop 0
    s_cmp_ge_u32 s78, 4
    s_cbranch_scc1 LD_66
    s_sleep 4
    s_sub_u32 s79, s79, 1
    s_cmp_lg_u32 s79, 0
    s_cbranch_scc1 LW_65
LD_66:
    s_mov_b64 exec, 1
    ds_add_u32 v14, v15 offset:20
    s_mov_b64 exec, -1
    s_mov_b32 s68, s26
    s_mov_b32 s69, s27
    s_mov_b32 s70, 401408
    s_mov_b32 s71, 0x00020000
    buffer_load_dword v126, v0, s[68:71], 0 offen
    s_waitcnt vmcnt(0)
    s_mov_b32 s68, s28
    s_mov_b32 s69, s29
    s_mov_b32 s70, 401408
    s_mov_b32 s71, 0x00020000
    buffer_load_dword v126, v0, s[68:71], 0 offen
    s_waitcnt vmcnt(0)
    s_mov_b32 s68, s42
    s_mov_b32 s69, s43
    s_mov_b32 s70, 401408
    s_mov_b32 s71, 0x00020000
    buffer_load_dword v126, v0, s[68:71], 0 offen
    s_waitcnt vmcnt(0)
    s_endpgm
F_END:
    s_endpgm
.p2align 8
.fill 4096, 4, 0xbf800000
.section .rodata,"a"
.p2align 6
.amdhsa_kernel concat_heads__ssm_conv_s5__grouped_kv_mqa__prompt_kernel
  .amdhsa_next_free_vgpr 256
  .amdhsa_next_free_sgpr 102
  .amdhsa_accum_offset 256
  .amdhsa_group_segment_fixed_size 0
  .amdhsa_kernarg_size 136
  .amdhsa_user_sgpr_count 2
  .amdhsa_user_sgpr_kernarg_segment_ptr 1
  .amdhsa_system_sgpr_workgroup_id_x 1
  .amdhsa_float_denorm_mode_32 3
.end_amdhsa_kernel
```
